```python
import torch

def _softmax(x, axis=-1):
    return torch.softmax(x, dim=axis)
def _gelu(x):
    return torch.nn.functional.gelu(x, approximate="tanh")
def _silu(x):
    return torch.nn.functional.silu(x)
def _sigmoid(x):
    return torch.sigmoid(x)
def _layernorm(x, axis=-1, eps=1e-5):
    m = x.mean(dim=axis, keepdim=True)
    v = x.var(dim=axis, keepdim=True, unbiased=False)
    return (x - m) / torch.sqrt(v + eps)
def _scatter_add(tgt, idx, src, axis=0):
    return tgt.clone().index_add_(axis, idx, src)
def _segment_sum(src, seg, n):
    out = torch.zeros((n,) + src.shape[1:], dtype=src.dtype)
    return out.index_add_(0, seg, src)
def _pad(x, pw):
    flat = tuple(v for pair in reversed(pw) for v in pair)
    return torch.nn.functional.pad(x, flat)

kernel_name = 'interleave_layers__mha_block_cached__compressed_kv_cla__decode'

def setup_inputs():

    _w = (lambda a: (lambda t: t.to(torch.bfloat16) if t.is_floating_point() else t)(torch.as_tensor(a)))
    def _A_setup():
        B, Sq, D = 2, 1, 512
        H, Sk, Dh = 32, 4096, 128
        return {
            "x": _w((lambda *s: torch.randn(*s, dtype=torch.bfloat16) * 0.1)(B, Sq, D)),
            "k_cache": _w((lambda *s: torch.randn(*s, dtype=torch.bfloat16) * 0.8)(B, H, Sk, Dh)),
            "v_cache": _w((lambda *s: torch.randn(*s, dtype=torch.bfloat16) * 1.6)(B, H, Sk, Dh)),
            "wq": _w((lambda *s: torch.randn(*s, dtype=torch.bfloat16) * 0.8)(D, H * Dh) * (D ** -0.5)),
            "wo": _w((lambda *s: torch.randn(*s, dtype=torch.bfloat16) * 1.6)(H * Dh, D) * ((H * Dh) ** -0.5)),
        }
    _A_in = _A_setup()

    def _B_setup():
        B, H, Sq, Sk, D, M = 2, 32, 1, 4096, 128, 512
        Dc = 4 * D
        return {
            "x": _w((lambda *s: torch.randn(*s, dtype=torch.bfloat16) * 0.1)(B, Sq, M)),
            "c_kv": _w((lambda *s: torch.randn(*s, dtype=torch.bfloat16) * 0.8)(B, Sk, Dc)),
            "w_q": _w((lambda *s: torch.randn(*s, dtype=torch.bfloat16) * 1.6)(M, H, D) * (M ** -0.5)),
            "w_uk": _w((lambda *s: torch.randn(*s, dtype=torch.bfloat16) * 1.6)(Dc, H, D) * (Dc ** -0.5)),
            "w_uv": _w((lambda *s: torch.randn(*s, dtype=torch.bfloat16) * 0.8)(Dc, H, D) * (Dc ** -0.5)),
            "w_o": _w((lambda *s: torch.randn(*s, dtype=torch.bfloat16) * 0.8)(H, D, M) * ((H * D) ** -0.5)),
        }
    _B_in = _B_setup()

    return {
        "A_x": _A_in["x"],
        "A_k_cache": _A_in["k_cache"],
        "A_v_cache": _A_in["v_cache"],
        "A_wq": _A_in["wq"],
        "A_wo": _A_in["wo"],
        "B_x": _B_in["x"],
        "B_c_kv": _B_in["c_kv"],
        "B_w_q": _B_in["w_q"],
        "B_w_uk": _B_in["w_uk"],
        "B_w_uv": _B_in["w_uv"],
        "B_w_o": _B_in["w_o"],
    }

def reference(A_x, A_k_cache, A_v_cache, A_wq, A_wo, B_x, B_c_kv, B_w_q, B_w_uk, B_w_uv, B_w_o):
    def _A_ref(x, k_cache, v_cache, wq, wo):
        B, Sq, D = x.shape
        H, Dh = 32, 128
        q = (lambda x, *d: x.permute(*d))((x @ wq).reshape(B, Sq, H, Dh), 0, 2, 1, 3)
        scores = torch.einsum("bhqd,bhkd->bhqk", q, k_cache) * (Dh ** -0.5)
        p = _softmax(scores, axis=-1)
        o = torch.einsum("bhqk,bhkd->bhqd", p, v_cache)
        return (lambda x, *d: x.permute(*d))(o, 0, 2, 1, 3).reshape(B, Sq, H * Dh) @ wo

    def _B_ref(x, c_kv, w_q, w_uk, w_uv, w_o):
        B, Sq, M = x.shape[0], x.shape[1], x.shape[2]
        Sk = c_kv.shape[1]
        H, D = w_q.shape[1], w_q.shape[2]
        q = torch.einsum("bqm,mhd->bhqd", x, w_q)
        k = torch.einsum("bkc,chd->bhkd", c_kv, w_uk)
        v = torch.einsum("bkc,chd->bhkd", c_kv, w_uv)
        scores = torch.einsum("bhqd,bhkd->bhqk", q, k) * (D ** -0.5)
        off = Sk - Sq
        qi = torch.arange(Sq)[:, None]
        kj = torch.arange(Sk)[None, :]
        cmask = kj <= (qi + off)
        scores = torch.where(cmask[None, None], scores, -1e9)
        p = _softmax(scores, axis=-1)
        ctx = torch.einsum("bhqk,bhkd->bhqd", p, v)
        return torch.einsum("bhqd,hdm->bqm", ctx, w_o)

    x = A_x
    x = x + _A_ref(_layernorm(x, axis=-1), A_k_cache, A_v_cache, A_wq, A_wo)
    x = x + _B_ref(_layernorm(x, axis=-1), B_c_kv, B_w_q, B_w_uk, B_w_uv, B_w_o)
    x = x + _A_ref(_layernorm(x, axis=-1), A_k_cache, A_v_cache, A_wq, A_wo)
    x = x + _B_ref(_layernorm(x, axis=-1), B_c_kv, B_w_q, B_w_uk, B_w_uv, B_w_o)
    return x
```

```asm
; @launch grid=(256,1,1) block=(256,1,1) lds=163840
.amdgcn_target "amdgcn-amd-amdhsa--gfx950"
.text
.globl interleave_layers__mha_block_cached__compressed_kv_cla__decode_kernel
.p2align 8
.type interleave_layers__mha_block_cached__compressed_kv_cla__decode_kernel,@function
interleave_layers__mha_block_cached__compressed_kv_cla__decode_kernel:
  s_cmp_ge_u32 s2, 256
  s_cbranch_scc1 Lend
  s_load_dwordx16 s[4:19], s[0:1], 0
  s_load_dwordx8 s[20:27], s[0:1], 64
  s_load_dwordx4 s[28:31], s[0:1], 96
  v_lshrrev_b32 v1, 6, v0
  v_and_b32 v0, 63, v0
  v_readfirstlane_b32 s34, v1
  v_lshlrev_b32 v1, 4, v0
  v_mov_b32 v3, 0
  s_mov_b32 s35, 0
  s_mov_b32 s62, 0
  s_getreg_b32 s36, hwreg(HW_REG_XCC_ID, 0, 4)
  s_mul_i32 s61, s36, s36
  s_lshl_b32 s61, s61, 8
  s_add_u32 s61, s61, s36
  s_lshl_b32 s61, s61, 8
  s_add_u32 s61, s61, 1
  s_mov_b32 s37, 0x200000
  s_mov_b32 s50, 0x3e0293ee
  s_and_b32 s32, s2, 31
  s_lshr_b32 s33, s2, 5
  v_lshrrev_b32 v2, 4, v0
  v_lshlrev_b32 v2, 4, v2
  v_xor_b32 v248, v1, v2
  v_xor_b32 v249, 64, v248
  v_xor_b32 v250, 128, v248
  v_xor_b32 v251, 192, v248
  s_lshl_b32 s63, s34, 14
  s_add_u32 s63, s63, 98304
  s_lshl_b32 s39, s32, 8
  s_lshr_b32 s36, s34, 1
  s_lshl_b32 s36, s36, 5
  s_and_b32 s38, s34, 1
  s_lshl_b32 s38, s38, 2
  s_add_u32 s38, s38, s36
  s_lshl_b32 s36, s33, 6
  s_add_u32 s38, s38, s36
  s_mul_i32 s51, s34, 21504
  s_lshl_b32 s55, s32, 3
  s_add_u32 s55, s55, s33
  s_lshr_b32 s36, s33, 2
  s_lshl_b32 s36, s36, 5
  s_add_u32 s36, s36, s32
  s_lshl_b32 s36, s36, 2
  s_and_b32 s46, s33, 3
  s_add_u32 s36, s36, s46
  s_lshl_b32 s36, s36, 2
  s_add_u32 s36, s36, s34
  s_mov_b32 s70, s36
  s_and_b32 s46, s36, 15
  s_lshr_b32 s36, s36, 4
  s_lshl_b32 s36, s36, 8
  s_add_u32 s36, s36, s46
  s_lshl_b32 s36, s36, 12
  s_mov_b32 s70, 0
  s_and_b32 s70, s70, 15
  s_mul_i32 s70, s70, 65536
  s_mov_b32 s71, s70
  s_lshl_b32 s46, s2, 2
  s_add_u32 s46, s46, s34
  s_lshl_b32 s56, s46, 11
  s_add_u32 s46, s56, 0x80000
  v_add_u32 v2, s46, v1
  v_mov_b32 v60, -1
  v_mov_b32 v61, -1
  v_mov_b32 v62, -1
  v_mov_b32 v63, -1
  s_waitcnt lgkmcnt(0)
  s_add_u32 s6, s6, s36
  s_addc_u32 s7, s7, 0
  s_add_u32 s8, s8, s36
  s_addc_u32 s9, s9, 0
  s_mov_b64 s[66:67], s[6:7]
  s_mov_b64 s[68:69], s[8:9]
  s_add_u32 s6, s6, s70
  s_addc_u32 s7, s7, 0
  s_add_u32 s8, s8, s70
  s_addc_u32 s9, s9, 0
  s_add_u32 m0, s63, 0
  s_nop 0
  global_load_lds_dwordx4 v248, s[6:7] offset:0 nt
  global_load_lds_dwordx4 v249, s[6:7] offset:1024 nt
  global_load_lds_dwordx4 v250, s[6:7] offset:2048 nt
  global_load_lds_dwordx4 v251, s[6:7] offset:3072 nt
  s_add_u32 s6, s6, 65536
  s_addc_u32 s7, s7, 0
  s_add_u32 m0, s63, 4096
  s_nop 0
  global_load_lds_dwordx4 v248, s[6:7] offset:0 nt
  global_load_lds_dwordx4 v249, s[6:7] offset:1024 nt
  global_load_lds_dwordx4 v250, s[6:7] offset:2048 nt
  global_load_lds_dwordx4 v251, s[6:7] offset:3072 nt
  s_add_u32 s6, s6, 65536
  s_addc_u32 s7, s7, 0
  s_add_u32 m0, s63, 8192
  s_nop 0
  global_load_lds_dwordx4 v248, s[6:7] offset:0 nt
  global_load_lds_dwordx4 v249, s[6:7] offset:1024 nt
  global_load_lds_dwordx4 v250, s[6:7] offset:2048 nt
  global_load_lds_dwordx4 v251, s[6:7] offset:3072 nt
  s_add_u32 s6, s6, 65536
  s_addc_u32 s7, s7, 0
  s_add_u32 m0, s63, 12288
  s_nop 0
  global_load_lds_dwordx4 v248, s[6:7] offset:0 nt
  global_load_lds_dwordx4 v249, s[6:7] offset:1024 nt
  global_load_lds_dwordx4 v250, s[6:7] offset:2048 nt
  global_load_lds_dwordx4 v251, s[6:7] offset:3072 nt
  s_add_u32 s6, s6, 65536
  s_addc_u32 s7, s7, 0
  s_mov_b64 s[40:41], s[30:31]
  s_mov_b64 s[42:43], s[30:31]
  s_add_u32 s44, s30, 0x500000
  s_addc_u32 s45, s31, 0
  s_lshr_b32 s36, s2, 7
  s_lshl_b32 s36, s36, 6
  s_and_b32 s46, s2, 63
  s_add_u32 s36, s36, s46
  s_lshl_b32 s36, s36, 8
  s_add_u32 s36, s36, s34
  s_lshl_b32 s36, s36, 8
  s_add_u32 s16, s16, s36
  s_addc_u32 s17, s17, 0
  s_lshr_b32 s36, s34, 1
  s_lshl_b32 s36, s36, 8
  s_add_u32 s36, s36, s55
  s_lshl_b32 s36, s36, 1
  s_and_b32 s46, s34, 1
  s_add_u32 s36, s36, s46
  s_lshl_b32 s36, s36, 12
  s_add_u32 s64, s44, s36
  s_addc_u32 s65, s45, 0
  s_add_u32 s46, s56, 0x80000
  v_add_u32 v2, s46, v1
  global_store_dwordx4 v2, v[60:63], s[30:31] offset:0 sc1
  global_store_dwordx4 v2, v[60:63], s[30:31] offset:1024 sc1
  s_cmp_gt_u32 s34, 1
  s_cbranch_scc1 Lqf
  s_lshl_b32 s36, s55, 1
  s_and_b32 s46, s34, 1
  s_add_u32 s36, s36, s46
  s_lshl_b32 s36, s36, 10
  v_add_u32 v2, s36, v1
  global_store_dwordx4 v2, v[60:63], s[30:31] sc1
Lqf:
  v_lshrrev_b32 v64, 4, v0
  v_add_u32 v64, s38, v64
  v_and_b32 v2, 8, v0
  v_lshlrev_b32 v2, 6, v2
  v_add_lshl_u32 v64, v64, v2, 1
  v_mov_b32 v8, 0
  v_mov_b32 v9, 0
  v_mov_b32 v10, 0
  v_mov_b32 v11, 0
  global_load_short_d16_hi v8, v64, s[4:5] offset:0
  global_load_short_d16_hi v9, v64, s[4:5] offset:16
  global_load_short_d16_hi v10, v64, s[4:5] offset:32
  global_load_short_d16_hi v11, v64, s[4:5] offset:48
  v_lshrrev_b32 v65, 4, v0
  v_add_u32 v65, s38, v65
  v_lshlrev_b32 v65, 13, v65
  v_and_b32 v2, 0xf0, v1
  v_add3_u32 v65, v65, v2, s39
  global_load_dwordx4 v[12:15], v65, s[10:11]
  v_add_u32 v65, 65536, v65
  global_load_dwordx4 v[16:19], v65, s[10:11]
  v_add_u32 v65, 65536, v65
  global_load_dwordx4 v[20:23], v65, s[10:11]
  v_add_u32 v65, 65536, v65
  global_load_dwordx4 v[24:27], v65, s[10:11]
  s_add_u32 m0, s51, 12288
  s_nop 0
  global_load_lds_dwordx4 v1, s[8:9] offset:0 nt
  global_load_dwordx4 v[84:87], v1, s[8:9] offset:1024 nt
  global_load_dwordx4 v[88:91], v1, s[8:9] offset:2048 nt
  s_add_u32 m0, s51, 11264
  s_nop 0
  global_load_lds_dwordx4 v1, s[8:9] offset:3072 nt
  s_add_u32 s8, s8, 65536
  s_addc_u32 s9, s9, 0
  v_and_b32 v2, 3, v0
  v_mul_u32_u24 v252, 0x440, v2
  v_bfe_u32 v2, v0, 2, 2
  v_mul_u32_u24 v2, 0x110, v2
  v_add_u32 v252, v252, v2
  v_and_b32 v2, 48, v0
  v_xor_b32 v252, v252, v2
  v_add_u32 v252, s63, v252
  v_xor_b32 v253, 64, v252
  v_xor_b32 v254, 128, v252
  v_xor_b32 v255, 192, v252
  v_and_b32 v2, 1, v0
  v_cmp_eq_u32 vcc, 1, v2
  v_mov_b32 v66, 0xffff
  v_mov_b32 v67, 0xffff0000
  v_cndmask_b32 v66, v66, v67, vcc
  v_bfe_u32 v2, v0, 1, 2
  v_cmp_eq_u32 vcc, 0, v2
  s_nop 1
  v_cndmask_b32 v4, 0, v66, vcc
  v_cmp_eq_u32 vcc, 1, v2
  s_nop 1
  v_cndmask_b32 v5, 0, v66, vcc
  v_cmp_eq_u32 vcc, 2, v2
  s_nop 1
  v_cndmask_b32 v6, 0, v66, vcc
  v_cmp_eq_u32 vcc, 3, v2
  s_nop 1
  v_cndmask_b32 v7, 0, v66, vcc
  s_waitcnt vmcnt(4)
Lloop:
  s_cmp_eq_u32 s35, 4
  s_cbranch_scc1 Lnocs
  v_and_b32 v60, 0x3f803f80, v4
  v_and_b32 v61, 0x3f803f80, v5
  v_and_b32 v62, 0x3f803f80, v6
  v_and_b32 v63, 0x3f803f80, v7
  s_nop 1
  v_mfma_f32_16x16x32_bf16 v[64:67], v[12:15], v[60:63], 0
  v_mfma_f32_16x16x32_bf16 v[64:67], v[16:19], v[60:63], v[64:67]
  v_mfma_f32_16x16x32_bf16 v[64:67], v[20:23], v[60:63], v[64:67]
  v_mfma_f32_16x16x32_bf16 v[64:67], v[24:27], v[60:63], v[64:67]
  s_mul_i32 s36, s34, 528
  s_add_u32 s36, s36, 4096
  v_lshrrev_b32 v2, 1, v1
  v_and_b32 v2, 0x180, v2
  v_and_b32 v68, 0x70, v1
  v_add3_u32 v68, v68, v2, s36
  v_lshrrev_b32 v69, 2, v0
  v_and_b32 v69, 8, v69
  v_lshrrev_b32 v2, 1, v0
  v_and_b32 v2, 4, v2
  v_add3_u32 v69, v69, v2, s36
  s_lshl_b32 s36, s34, 10
  s_add_u32 s36, s36, 0
  v_add_u32 v70, s36, v1
  ds_write_b128 v68, v[64:67]
Lnocs:
  s_cmp_eq_u32 s35, 0
  s_cbranch_scc1 Lx0
  s_lshl_b32 s36, s33, 7
  s_add_u32 s36, s36, s34
  s_lshl_b32 s36, s36, 7
  s_add_u32 s36, s36, 786432
  v_lshrrev_b32 v71, 3, v0
  v_lshlrev_b32 v71, 11, v71
  v_and_b32 v2, 0x70, v1
  v_add3_u32 v71, v71, v2, s36
  s_lshl_b32 s36, s34, 10
  s_add_u32 s36, s36, 8192
  v_lshrrev_b32 v73, 2, v0
  v_and_b32 v73, 12, v73
  v_add3_u32 v73, v73, v2, s36
  v_and_b32 v74, 48, v0
  v_lshlrev_b32 v2, 3, v0
  v_and_b32 v2, 64, v2
  v_add3_u32 v74, v74, v2, s36
  s_lshl_b32 s36, s32, 2
  s_add_u32 s36, s36, s34
  s_lshl_b32 s36, s36, 8
  s_add_u32 s36, s36, s33
  s_lshl_b32 s36, s36, 7
  v_lshrrev_b32 v75, 3, v0
  v_lshlrev_b32 v75, 10, v75
  v_and_b32 v2, 0x70, v1
  v_add3_u32 v75, v75, v2, s36
  s_branch Lp1
Lp1r:
  s_sub_u32 s37, s37, 1
  s_cbranch_scc1 Lend
Lp1:
  global_load_dwordx4 v[44:47], v71, s[42:43] offset:0 sc1
  global_load_dwordx4 v[48:51], v71, s[42:43] offset:512 sc1
  global_load_dwordx4 v[52:55], v71, s[42:43] offset:1024 sc1
  global_load_dwordx4 v[56:59], v71, s[42:43] offset:1536 sc1
  s_waitcnt vmcnt(0)
Lp1c:
  v_max3_u32 v72, v44, v45, v46
  v_max3_u32 v72, v72, v47, v48
  v_max3_u32 v72, v72, v49, v50
  v_max3_u32 v72, v72, v51, v52
  v_max3_u32 v72, v72, v53, v54
  v_max3_u32 v72, v72, v55, v56
  v_max3_u32 v72, v72, v57, v58
  v_max3_u32 v72, v72, v59, v59
  v_cmp_eq_u32 vcc, -1, v72
  s_cbranch_vccnz Lp1r
  s_cmp_lg_u32 s35, 2
  s_cbranch_scc1 Ly2
  global_load_dwordx4 v[28:31], v75, s[12:13]
  v_add_u32 v75, 8192, v75
  global_load_dwordx4 v[32:35], v75, s[12:13]
  v_add_u32 v75, 8192, v75
  global_load_dwordx4 v[36:39], v75, s[12:13]
  v_add_u32 v75, 8192, v75
  global_load_dwordx4 v[40:43], v75, s[12:13]
Ly2:
  v_pk_add_f32 v[44:45], v[44:45], v[48:49]
  v_pk_add_f32 v[52:53], v[52:53], v[56:57]
  v_pk_add_f32 v[46:47], v[46:47], v[50:51]
  v_pk_add_f32 v[54:55], v[54:55], v[58:59]
  v_pk_add_f32 v[44:45], v[44:45], v[52:53]
  v_pk_add_f32 v[46:47], v[46:47], v[54:55]
  s_nop 1
  v_permlane32_swap_b32 v44, v46
  v_permlane32_swap_b32 v45, v47
  v_add_f32 v44, v44, v46
  v_add_f32 v45, v45, v47
  s_nop 1
  v_permlane16_swap_b32 v44, v45
  v_add_f32 v44, v44, v45
  s_nop 1
  v_add_f32_dpp v44, v44, v44 row_ror:8 row_mask:0xf bank_mask:0xf
  v_cvt_pk_bf16_f32 v44, 0, v44
  ds_write_b32 v73, v44
  ds_read_b128 v[44:47], v74
  s_waitcnt lgkmcnt(0)
  v_add_f32 v8, v8, v44
  v_add_f32 v9, v9, v45
  v_add_f32 v10, v10, v46
  v_add_f32 v11, v11, v47
Lx0:
  v_cvt_pk_bf16_f32 v44, v8, v8
  v_cvt_pk_bf16_f32 v45, v9, v9
  v_cvt_pk_bf16_f32 v46, v10, v10
  v_cvt_pk_bf16_f32 v47, v11, v11
  s_cmp_eq_u32 s35, 4
  s_cbranch_scc1 Lout
  v_and_b32 v48, v44, v4
  v_and_b32 v49, v44, v5
  v_and_b32 v50, v44, v6
  v_and_b32 v51, v44, v7
  s_nop 1
  v_mfma_f32_16x16x32_bf16 v[64:67], v[12:15], v[48:51], 0
  v_and_b32 v52, v45, v4
  v_and_b32 v53, v45, v5
  v_and_b32 v54, v45, v6
  v_and_b32 v55, v45, v7
  s_nop 1
  v_mfma_f32_16x16x32_bf16 v[64:67], v[16:19], v[52:55], v[64:67]
  v_and_b32 v48, v46, v4
  v_and_b32 v49, v46, v5
  v_and_b32 v50, v46, v6
  v_and_b32 v51, v46, v7
  s_nop 1
  v_mfma_f32_16x16x32_bf16 v[64:67], v[20:23], v[48:51], v[64:67]
  v_and_b32 v52, v47, v4
  v_and_b32 v53, v47, v5
  v_and_b32 v54, v47, v6
  v_and_b32 v55, v47, v7
  s_nop 1
  v_mfma_f32_16x16x32_bf16 v[64:67], v[24:27], v[52:55], v[64:67]
  v_and_b32 v8, 0xffff0000, v44
  v_and_b32 v9, 0xffff0000, v45
  v_and_b32 v10, 0xffff0000, v46
  v_and_b32 v11, 0xffff0000, v47
  v_add_f32 v60, v8, v9
  v_mul_f32 v61, v8, v8
  v_add_f32 v60, v60, v10
  v_fmac_f32 v61, v9, v9
  v_add_f32 v60, v60, v11
  v_fmac_f32 v61, v10, v10
  v_fmac_f32 v61, v11, v11
  ds_write_b128 v70, v[64:67]
  s_nop 0
  v_permlane32_swap_b32 v60, v61
  v_add_f32 v60, v60, v61
  v_mov_b32 v61, v60
  s_nop 1
  v_permlane16_swap_b32 v60, v61
  v_add_f32 v60, v60, v61
  ds_write_b32 v69, v60 offset:512
  s_lshl_b32 s36, s55, 11
  v_add_u32 v71, s36, v1
  v_and_b32 v2, 8, v0
  v_cmp_eq_u32 vcc, 0, v2
  v_mov_b32 v2, 5136
  s_nop 0
  v_cndmask_b32 v68, v2, v68, vcc
  v_subrev_u32 v68, 528, v68
  s_waitcnt lgkmcnt(0)
  s_barrier
  s_cmp_eq_u32 s34, 0
  s_cbranch_scc0 Lxq1
  ds_read_b128 v[44:47], v70 offset:0
  ds_read_b128 v[48:51], v70 offset:1024
  ds_read_b128 v[52:55], v70 offset:2048
  ds_read_b128 v[56:59], v70 offset:3072
  s_waitcnt lgkmcnt(2)
  v_pk_add_f32 v[44:45], v[44:45], v[48:49]
  v_pk_add_f32 v[46:47], v[46:47], v[50:51]
  s_waitcnt lgkmcnt(0)
  v_pk_add_f32 v[52:53], v[52:53], v[56:57]
  v_pk_add_f32 v[54:55], v[54:55], v[58:59]
  v_pk_add_f32 v[44:45], v[44:45], v[52:53]
  v_pk_add_f32 v[46:47], v[46:47], v[54:55]
  s_cmp_eq_u32 s62, 0
  s_cbranch_scc1 Ls1
  global_store_dwordx4 v71, v[44:47], s[40:41]
  s_branch Ls1e
Ls1:
  global_store_dwordx4 v71, v[44:47], s[40:41] sc1
Ls1e:
  s_branch Lxq3
Lxq1:
  s_cmp_eq_u32 s34, 1
  s_cbranch_scc0 Lxq2
  ds_read_b128 v[44:47], v68 offset:0
  ds_read_b128 v[48:51], v68 offset:528
  ds_read_b128 v[52:55], v68 offset:1056
  ds_read_b128 v[56:59], v68 offset:1584
  s_waitcnt lgkmcnt(2)
  v_pk_add_f32 v[44:45], v[44:45], v[48:49]
  v_pk_add_f32 v[46:47], v[46:47], v[50:51]
  s_waitcnt lgkmcnt(0)
  v_pk_add_f32 v[52:53], v[52:53], v[56:57]
  v_pk_add_f32 v[54:55], v[54:55], v[58:59]
  v_pk_add_f32 v[44:45], v[44:45], v[52:53]
  v_pk_add_f32 v[46:47], v[46:47], v[54:55]
  s_cmp_eq_u32 s62, 0
  s_cbranch_scc1 Ls2
  global_store_dwordx4 v71, v[44:47], s[40:41] offset:1024
  s_branch Ls2e
Ls2:
  global_store_dwordx4 v71, v[44:47], s[40:41] offset:1024 sc1
Ls2e:
  s_branch Lxq3
Lxq2:
  s_add_u32 s36, s34, s35
  s_cmp_eq_u32 s36, 2
  s_cbranch_scc0 Lxq3
  s_lshl_b32 s36, s32, 2
  v_mov_b32 v2, s36
  v_mov_b32 v60, s61
  s_mov_b64 exec, 1
  global_atomic_add v2, v60, s[28:29] sc1
  s_mov_b64 exec, -1
Lxq3:
  s_cmp_lg_u32 s35, 0
  s_cbranch_scc1 Lq0
  s_waitcnt vmcnt(12)
  ds_read_b128 a[0:3], v252 offset:0
  ds_read_b128 a[4:7], v253 offset:0
  ds_read_b128 a[8:11], v254 offset:0
  ds_read_b128 a[12:15], v255 offset:0
  s_waitcnt lgkmcnt(0)
  s_add_u32 m0, s63, 0
  s_nop 0
  global_load_lds_dwordx4 v248, s[6:7] offset:0 nt
  global_load_lds_dwordx4 v249, s[6:7] offset:1024 nt
  global_load_lds_dwordx4 v250, s[6:7] offset:2048 nt
  global_load_lds_dwordx4 v251, s[6:7] offset:3072 nt
  s_add_u32 s6, s6, 65536
  s_addc_u32 s7, s7, 0
  s_waitcnt vmcnt(12)
  ds_read_b128 a[16:19], v252 offset:4096
  ds_read_b128 a[20:23], v253 offset:4096
  ds_read_b128 a[24:27], v254 offset:4096
  ds_read_b128 a[28:31], v255 offset:4096
  s_waitcnt lgkmcnt(0)
  s_add_u32 m0, s63, 4096
  s_nop 0
  global_load_lds_dwordx4 v248, s[6:7] offset:0 nt
  global_load_lds_dwordx4 v249, s[6:7] offset:1024 nt
  global_load_lds_dwordx4 v250, s[6:7] offset:2048 nt
  global_load_lds_dwordx4 v251, s[6:7] offset:3072 nt
  s_add_u32 s6, s6, 65536
  s_addc_u32 s7, s7, 0
  s_waitcnt vmcnt(12)
  ds_read_b128 a[32:35], v252 offset:8192
  ds_read_b128 a[36:39], v253 offset:8192
  ds_read_b128 a[40:43], v254 offset:8192
  ds_read_b128 a[44:47], v255 offset:8192
  s_waitcnt lgkmcnt(0)
  s_add_u32 m0, s63, 8192
  s_nop 0
  global_load_lds_dwordx4 v248, s[6:7] offset:0 nt
  global_load_lds_dwordx4 v249, s[6:7] offset:1024 nt
  global_load_lds_dwordx4 v250, s[6:7] offset:2048 nt
  global_load_lds_dwordx4 v251, s[6:7] offset:3072 nt
  s_add_u32 s6, s6, 65536
  s_addc_u32 s7, s7, 0
  s_waitcnt vmcnt(12)
  ds_read_b128 a[48:51], v252 offset:12288
  ds_read_b128 a[52:55], v253 offset:12288
  ds_read_b128 a[56:59], v254 offset:12288
  ds_read_b128 a[60:63], v255 offset:12288
  s_waitcnt lgkmcnt(0)
  s_add_u32 m0, s63, 12288
  s_nop 0
  global_load_lds_dwordx4 v248, s[6:7] offset:0 nt
  global_load_lds_dwordx4 v249, s[6:7] offset:1024 nt
  global_load_lds_dwordx4 v250, s[6:7] offset:2048 nt
  global_load_lds_dwordx4 v251, s[6:7] offset:3072 nt
  s_add_u32 s6, s6, 65536
  s_addc_u32 s7, s7, 0
  s_waitcnt vmcnt(12)
  ds_read_b128 a[64:67], v252 offset:0
  ds_read_b128 a[68:71], v253 offset:0
  ds_read_b128 a[72:75], v254 offset:0
  ds_read_b128 a[76:79], v255 offset:0
  s_waitcnt lgkmcnt(0)
  s_add_u32 m0, s63, 0
  s_nop 0
  global_load_lds_dwordx4 v248, s[6:7] offset:0 nt
  global_load_lds_dwordx4 v249, s[6:7] offset:1024 nt
  global_load_lds_dwordx4 v250, s[6:7] offset:2048 nt
  global_load_lds_dwordx4 v251, s[6:7] offset:3072 nt
  s_add_u32 s6, s6, 65536
  s_addc_u32 s7, s7, 0
  s_waitcnt vmcnt(12)
  ds_read_b128 a[80:83], v252 offset:4096
  ds_read_b128 a[84:87], v253 offset:4096
  ds_read_b128 a[88:91], v254 offset:4096
  ds_read_b128 a[92:95], v255 offset:4096
  s_waitcnt lgkmcnt(0)
  s_add_u32 m0, s63, 4096
  s_nop 0
  global_load_lds_dwordx4 v248, s[6:7] offset:0 nt
  global_load_lds_dwordx4 v249, s[6:7] offset:1024 nt
  global_load_lds_dwordx4 v250, s[6:7] offset:2048 nt
  global_load_lds_dwordx4 v251, s[6:7] offset:3072 nt
  s_add_u32 s6, s6, 65536
  s_addc_u32 s7, s7, 0
  s_waitcnt vmcnt(12)
  ds_read_b128 a[96:99], v252 offset:8192
  ds_read_b128 a[100:103], v253 offset:8192
  ds_read_b128 a[104:107], v254 offset:8192
  ds_read_b128 a[108:111], v255 offset:8192
  s_waitcnt lgkmcnt(0)
  s_add_u32 m0, s63, 8192
  s_nop 0
  global_load_lds_dwordx4 v248, s[6:7] offset:0 nt
  global_load_lds_dwordx4 v249, s[6:7] offset:1024 nt
  global_load_lds_dwordx4 v250, s[6:7] offset:2048 nt
  global_load_lds_dwordx4 v251, s[6:7] offset:3072 nt
  s_add_u32 s6, s6, 65536
  s_addc_u32 s7, s7, 0
  s_waitcnt vmcnt(12)
  ds_read_b128 a[112:115], v252 offset:12288
  ds_read_b128 a[116:119], v253 offset:12288
  ds_read_b128 a[120:123], v254 offset:12288
  ds_read_b128 a[124:127], v255 offset:12288
  s_waitcnt lgkmcnt(0)
  s_add_u32 m0, s63, 12288
  s_nop 0
  global_load_lds_dwordx4 v248, s[6:7] offset:0 nt
  global_load_lds_dwordx4 v249, s[6:7] offset:1024 nt
  global_load_lds_dwordx4 v250, s[6:7] offset:2048 nt
  global_load_lds_dwordx4 v251, s[6:7] offset:3072 nt
  s_add_u32 s6, s6, 65536
  s_addc_u32 s7, s7, 0
  v_and_b32 v61, 31, v0
  v_lshlrev_b32 v61, 2, v61
  global_load_dword v60, v61, s[28:29] sc1
  s_waitcnt vmcnt(12)
  ds_read_b128 a[128:131], v252 offset:0
  ds_read_b128 a[132:135], v253 offset:0
  ds_read_b128 a[136:139], v254 offset:0
  ds_read_b128 a[140:143], v255 offset:0
  s_waitcnt lgkmcnt(0)
  s_add_u32 m0, s63, 0
  s_nop 0
  global_load_lds_dwordx4 v248, s[6:7] offset:0 nt
  global_load_lds_dwordx4 v249, s[6:7] offset:1024 nt
  global_load_lds_dwordx4 v250, s[6:7] offset:2048 nt
  global_load_lds_dwordx4 v251, s[6:7] offset:3072 nt
  s_add_u32 s6, s6, 65536
  s_addc_u32 s7, s7, 0
  s_waitcnt vmcnt(12)
  ds_read_b128 a[144:147], v252 offset:4096
  ds_read_b128 a[148:151], v253 offset:4096
  ds_read_b128 a[152:155], v254 offset:4096
  ds_read_b128 a[156:159], v255 offset:4096
  s_waitcnt lgkmcnt(0)
  s_add_u32 m0, s63, 4096
  s_nop 0
  global_load_lds_dwordx4 v248, s[6:7] offset:0 nt
  global_load_lds_dwordx4 v249, s[6:7] offset:1024 nt
  global_load_lds_dwordx4 v250, s[6:7] offset:2048 nt
  global_load_lds_dwordx4 v251, s[6:7] offset:3072 nt
  s_add_u32 s6, s6, 65536
  s_addc_u32 s7, s7, 0
  s_waitcnt vmcnt(12)
  ds_read_b128 a[160:163], v252 offset:8192
  ds_read_b128 a[164:167], v253 offset:8192
  ds_read_b128 a[168:171], v254 offset:8192
  ds_read_b128 a[172:175], v255 offset:8192
  s_waitcnt lgkmcnt(0)
  s_add_u32 m0, s63, 8192
  s_nop 0
  global_load_lds_dwordx4 v248, s[6:7] offset:0 nt
  global_load_lds_dwordx4 v249, s[6:7] offset:1024 nt
  global_load_lds_dwordx4 v250, s[6:7] offset:2048 nt
  global_load_lds_dwordx4 v251, s[6:7] offset:3072 nt
  s_add_u32 s6, s6, 65536
  s_addc_u32 s7, s7, 0
  s_waitcnt vmcnt(12)
  ds_read_b128 a[176:179], v252 offset:12288
  ds_read_b128 a[180:183], v253 offset:12288
  ds_read_b128 a[184:187], v254 offset:12288
  ds_read_b128 a[188:191], v255 offset:12288
  s_waitcnt lgkmcnt(0)
  s_add_u32 m0, s63, 12288
  s_nop 0
  global_load_lds_dwordx4 v248, s[6:7] offset:0 nt
  global_load_lds_dwordx4 v249, s[6:7] offset:1024 nt
  global_load_lds_dwordx4 v250, s[6:7] offset:2048 nt
  global_load_lds_dwordx4 v251, s[6:7] offset:3072 nt
  s_add_u32 s6, s6, 65536
  s_addc_u32 s7, s7, 0
  s_waitcnt vmcnt(16)
Lcnt:
  v_and_b32 v2, 0xff, v60
  v_cmp_gt_u32 vcc, 8, v2
  s_cbranch_vccz Lq00
  s_sub_u32 s37, s37, 1
  s_cbranch_scc1 Lend
  global_load_dword v60, v61, s[28:29] sc1
  s_waitcnt vmcnt(0)
  s_branch Lcnt
Lq00:
  v_readlane_b32 s36, v60, s32
  s_lshl_b32 s61, s61, 3
  s_cmp_eq_u32 s36, s61
  s_cselect_b32 s62, 1, 0
Lq0:
  s_lshl_b32 s36, s32, 14
  s_lshl_b32 s46, s34, 8
  s_add_u32 s36, s36, s46
  s_add_u32 s36, s36, 0
  v_lshrrev_b32 v60, 3, v0
  v_lshlrev_b32 v60, 11, v60
  v_and_b32 v2, 0x70, v1
  v_add3_u32 v60, v60, v2, s36
  s_lshl_b32 s36, s34, 6
  s_add_u32 s36, s36, 6400
  v_and_b32 v61, 7, v0
  v_and_b32 v2, 48, v0
  v_lshl_add_u32 v61, v61, 1, v2
  v_and_b32 v2, 8, v0
  v_lshlrev_b32 v2, 5, v2
  v_add3_u32 v61, v61, v2, s36
  s_bitcmp1_b32 s35, 0
  s_cbranch_scc1 LqB
  s_lshr_b32 s36, s33, 2
  s_lshl_b32 s36, s36, 8
  v_mov_b32 v62, s36
  s_branch LqC
LqB:
  v_and_b32 v2, 1, v0
  v_lshlrev_b32 v62, 8, v2
  s_lshl_b32 s36, s33, 4
  s_add_u32 s36, s36, s34
  s_lshl_b32 s36, s36, 15
  s_add_u32 s36, s36, s39
  v_lshrrev_b32 v63, 4, v0
  v_lshlrev_b32 v63, 13, v63
  v_and_b32 v2, 0xf0, v1
  v_add3_u32 v63, v63, v2, s36
  s_lshl_b32 s36, s34, 10
  s_add_u32 s36, s36, 8192
  v_and_b32 v2, 48, v0
  v_xor_b32 v78, v2, v1
  v_add_u32 v78, s36, v78
  v_lshlrev_b32 v79, 2, v0
  v_xor_b32 v2, v79, v0
  v_and_b32 v2, 48, v2
  v_lshlrev_b32 v79, 2, v1
  v_and_b32 v79, 0x3c0, v79
  v_add3_u32 v79, v79, v2, s36
  ds_write_b128 v78, v[28:31]
  ds_read_b128 v[28:31], v79
  ds_write_b128 v78, v[32:35]
  ds_read_b128 v[32:35], v79
  ds_write_b128 v78, v[36:39]
  ds_read_b128 v[36:39], v79
  ds_write_b128 v78, v[40:43]
  ds_read_b128 v[40:43], v79
LqC:
  v_and_b32 v2, 48, v0
  v_add_u32 v2, 6400, v2
  v_add_u32 v62, v62, v2
  s_cmp_lg_u32 s35, 0
  s_cbranch_scc1 Lp2
  global_load_dwordx4 v[44:47], v60, s[40:41] offset:0 sc1
  global_load_dwordx4 v[48:51], v60, s[40:41] offset:128 sc1
  global_load_dwordx4 v[52:55], v60, s[40:41] offset:1024 sc1
  global_load_dwordx4 v[56:59], v60, s[40:41] offset:1152 sc1
  global_load_dwordx4 v[92:95], v1, s[8:9] offset:0 nt
  s_add_u32 m0, s51, 12288
  s_nop 0
  global_load_lds_dwordx4 v1, s[8:9] offset:1024 nt
  global_load_dwordx4 v[96:99], v1, s[8:9] offset:2048 nt
  global_load_dwordx4 v[100:103], v1, s[8:9] offset:3072 nt
  s_add_u32 s8, s8, 65536
  s_addc_u32 s9, s9, 0
  global_load_dwordx4 v[104:107], v1, s[8:9] offset:0 nt
  global_load_dwordx4 v[108:111], v1, s[8:9] offset:1024 nt
  s_add_u32 m0, s51, 14336
  s_nop 0
  global_load_lds_dwordx4 v1, s[8:9] offset:2048 nt
  global_load_dwordx4 v[112:115], v1, s[8:9] offset:3072 nt
  s_add_u32 s8, s8, 65536
  s_addc_u32 s9, s9, 0
  s_add_u32 m0, s51, 15360
  s_nop 0
  global_load_lds_dwordx4 v1, s[8:9] offset:0 nt
  global_load_dwordx4 v[116:119], v1, s[8:9] offset:1024 nt
  global_load_dwordx4 v[120:123], v1, s[8:9] offset:2048 nt
  s_add_u32 m0, s51, 14336
  s_nop 0
  global_load_lds_dwordx4 v1, s[8:9] offset:3072 nt
  s_add_u32 s8, s8, 65536
  s_addc_u32 s9, s9, 0
  s_waitcnt vmcnt(12)
  s_branch Lp2c
Lp2r:
  s_sub_u32 s37, s37, 1
  s_cbranch_scc1 Lend
Lp2:
  global_load_dwordx4 v[44:47], v60, s[40:41] offset:0 sc1
  global_load_dwordx4 v[48:51], v60, s[40:41] offset:128 sc1
  global_load_dwordx4 v[52:55], v60, s[40:41] offset:1024 sc1
  global_load_dwordx4 v[56:59], v60, s[40:41] offset:1152 sc1
  s_waitcnt vmcnt(0)
Lp2c:
  v_max3_u32 v64, v44, v45, v46
  v_max3_u32 v64, v64, v47, v48
  v_max3_u32 v64, v64, v49, v50
  v_max3_u32 v64, v64, v51, v52
  v_max3_u32 v64, v64, v53, v54
  v_max3_u32 v64, v64, v55, v56
  v_max3_u32 v64, v64, v57, v58
  v_max3_u32 v64, v64, v59, v59
  v_cmp_eq_u32 vcc, -1, v64
  s_cbranch_vccnz Lp2r
  s_cmp_lg_u32 s35, 0
  s_cbranch_scc1 Lq1
  global_load_dwordx4 v[124:127], v1, s[8:9] offset:0 nt
  s_add_u32 m0, s51, 17408
  s_nop 0
  global_load_lds_dwordx4 v1, s[8:9] offset:1024 nt
  global_load_dwordx4 v[128:131], v1, s[8:9] offset:2048 nt
  global_load_dwordx4 v[132:135], v1, s[8:9] offset:3072 nt
  s_add_u32 s8, s8, 65536
  s_addc_u32 s9, s9, 0
  global_load_dwordx4 v[136:139], v1, s[8:9] offset:0 nt
  global_load_dwordx4 v[140:143], v1, s[8:9] offset:1024 nt
  s_add_u32 m0, s51, 17408
  s_nop 0
  global_load_lds_dwordx4 v1, s[8:9] offset:2048 nt
  global_load_dwordx4 v[144:147], v1, s[8:9] offset:3072 nt
  s_add_u32 s8, s8, 65536
  s_addc_u32 s9, s9, 0
  s_add_u32 m0, s51, 20480
  s_nop 0
  global_load_lds_dwordx4 v1, s[8:9] offset:0 nt
  global_load_dwordx4 v[148:151], v1, s[8:9] offset:1024 nt
  global_load_dwordx4 v[152:155], v1, s[8:9] offset:2048 nt
  s_add_u32 m0, s51, 19456
  s_nop 0
  global_load_lds_dwordx4 v1, s[8:9] offset:3072 nt
  s_add_u32 s8, s8, 65536
  s_addc_u32 s9, s9, 0
  global_load_dwordx4 v[156:159], v1, s[8:9] offset:0 nt
  s_add_u32 m0, s51, 20480
  s_nop 0
  global_load_lds_dwordx4 v1, s[8:9] offset:1024 nt
  global_load_dwordx4 v[160:163], v1, s[8:9] offset:2048 nt
  global_load_dwordx4 v[164:167], v1, s[8:9] offset:3072 nt
  s_add_u32 s8, s8, 65536
  s_addc_u32 s9, s9, 0
  ds_read_b128 a[192:195], v252 offset:0
  ds_read_b128 a[196:199], v253 offset:0
  ds_read_b128 a[200:203], v254 offset:0
  ds_read_b128 a[204:207], v255 offset:0
  ds_read_b128 a[208:211], v252 offset:4096
  ds_read_b128 a[212:215], v253 offset:4096
  ds_read_b128 a[216:219], v254 offset:4096
  ds_read_b128 a[220:223], v255 offset:4096
  s_waitcnt lgkmcnt(4)
  ds_read_b128 a[224:227], v252 offset:8192
  ds_read_b128 a[228:231], v253 offset:8192
  ds_read_b128 a[232:235], v254 offset:8192
  ds_read_b128 a[236:239], v255 offset:8192
  ds_read_b128 a[240:243], v252 offset:12288
  ds_read_b128 a[244:247], v253 offset:12288
  ds_read_b128 a[248:251], v254 offset:12288
  ds_read_b128 a[252:255], v255 offset:12288
Lq1:
  s_bitcmp1_b32 s35, 0
  s_cbranch_scc0 Lq2
  global_load_dwordx4 v[12:15], v63, s[22:23]
  v_add_u32 v63, 131072, v63
  global_load_dwordx4 v[16:19], v63, s[22:23]
  v_add_u32 v63, 131072, v63
  global_load_dwordx4 v[20:23], v63, s[22:23]
  v_add_u32 v63, 131072, v63
  global_load_dwordx4 v[24:27], v63, s[22:23]
Lq2:
  v_permlane32_swap_b32 v56, v58
  v_permlane32_swap_b32 v57, v59
  v_permlane32_swap_b32 v44, v46
  v_permlane32_swap_b32 v45, v47
  v_permlane32_swap_b32 v48, v50
  v_permlane32_swap_b32 v49, v51
  v_permlane32_swap_b32 v52, v54
  v_permlane32_swap_b32 v53, v55
  v_add_f32 v56, v56, v58
  v_add_f32 v57, v57, v59
  v_add_f32 v44, v44, v46
  v_add_f32 v45, v45, v47
  v_add_f32 v48, v48, v50
  v_add_f32 v49, v49, v51
  v_add_f32 v52, v52, v54
  v_add_f32 v53, v53, v55
  v_permlane16_swap_b32 v56, v57
  v_permlane16_swap_b32 v44, v45
  v_permlane16_swap_b32 v48, v49
  v_permlane16_swap_b32 v52, v53
  v_add_f32 v56, v56, v57
  v_add_f32 v44, v44, v45
  v_add_f32 v48, v48, v49
  v_add_f32 v52, v52, v53
  v_add_f32_dpp v56, v56, v56 row_ror:8 row_mask:0xf bank_mask:0xf
  v_add_f32_dpp v44, v44, v44 row_ror:8 row_mask:0xf bank_mask:0xf
  v_add_f32_dpp v48, v48, v48 row_ror:8 row_mask:0xf bank_mask:0xf
  v_add_f32_dpp v52, v52, v52 row_ror:8 row_mask:0xf bank_mask:0xf
  s_mov_b32 s46, 0xff00ff00
  s_mov_b32 s47, 0xff00ff00
  v_readlane_b32 s57, v56, 0
  v_readlane_b32 s58, v56, 16
  v_readlane_b32 s59, v56, 32
  v_readlane_b32 s60, v56, 48
  v_cndmask_b32 v44, v44, v48, s[46:47]
  s_mov_b64 vcc, s[46:47]
  v_mov_b32 v56, s58
  v_mov_b32 v58, s60
  v_mov_b32 v57, 0x3727c5ac
  v_mov_b32 v45, s57
  v_mov_b32 v46, s59
  v_cndmask_b32 v56, v45, v56, vcc
  v_cndmask_b32 v58, v46, v58, vcc
  v_mul_f32 v56, 0x3b000000, v56
  v_fmac_f32 v57, 0x3b000000, v58
  v_fma_f32 v57, -v56, v56, v57
  v_rsq_f32 v57, v57
  v_fma_f32 v44, -v56, v52, v44
  v_mul_f32 v44, v44, v57
  v_cvt_pk_bf16_f32 v44, v44, v44
  ds_write_b16 v61, v44
  s_waitcnt lgkmcnt(0)
  s_barrier
  ds_read_b128 v[44:47], v62 offset:0
  ds_read_b128 v[48:51], v62 offset:64
  ds_read_b128 v[52:55], v62 offset:128
  ds_read_b128 v[56:59], v62 offset:192
  s_bitcmp1_b32 s35, 0
  s_cbranch_scc1 LB
  s_mov_b32 s46, 0x00010001
  s_mov_b32 s47, 0x00010001
  v_add_u32 v83, s51, v1
  s_lshl_b32 s36, s34, 10
  s_add_u32 s36, s36, 8192
  v_add_u32 v82, s36, v1
  v_and_b32 v2, 0x300, v1
  v_and_b32 v80, 8, v0
  v_lshl_add_u32 v2, v80, 1, v2
  v_add_u32 v2, s36, v2
  s_waitcnt lgkmcnt(0)
  s_cmp_eq_u32 s35, 0
  s_cbranch_scc1 Lcf
  v_mov_b32 v76, -1
  v_mov_b32 v77, -1
  v_mov_b32 v78, -1
  v_mov_b32 v79, -1
  global_store_dwordx4 v1, v[76:79], s[64:65] offset:0 sc1
  global_store_dwordx4 v1, v[76:79], s[64:65] offset:1024 sc1
  global_store_dwordx4 v1, v[76:79], s[64:65] offset:2048 sc1
  global_store_dwordx4 v1, v[76:79], s[64:65] offset:3072 sc1
Lcf:
  v_mfma_f32_16x16x32_bf16 v[60:63], a[0:3], v[44:47], 0
  v_mfma_f32_16x16x32_bf16 v[60:63], a[4:7], v[48:51], v[60:63]
  v_mfma_f32_16x16x32_bf16 v[60:63], a[8:11], v[52:55], v[60:63]
  v_mfma_f32_16x16x32_bf16 v[60:63], a[12:15], v[56:59], v[60:63]
  v_mfma_f32_16x16x32_bf16 v[64:67], a[16:19], v[44:47], 0
  v_mfma_f32_16x16x32_bf16 v[64:67], a[20:23], v[48:51], v[64:67]
  v_mfma_f32_16x16x32_bf16 v[64:67], a[24:27], v[52:55], v[64:67]
  v_mfma_f32_16x16x32_bf16 v[64:67], a[28:31], v[56:59], v[64:67]
  v_mfma_f32_16x16x32_bf16 v[72:75], a[32:35], v[44:47], 0
  s_nop 2
  v_cndmask_b32 v68, v68, v60, s[46:47]
  v_mfma_f32_16x16x32_bf16 v[72:75], a[36:39], v[48:51], v[72:75]
  v_cndmask_b32 v69, v69, v61, s[46:47]
  v_mfma_f32_16x16x32_bf16 v[72:75], a[40:43], v[52:55], v[72:75]
  v_cndmask_b32 v70, v70, v62, s[46:47]
  v_mfma_f32_16x16x32_bf16 v[72:75], a[44:47], v[56:59], v[72:75]
  v_cndmask_b32 v71, v71, v63, s[46:47]
  s_lshl_b64 s[46:47], s[46:47], 1
  v_mfma_f32_16x16x32_bf16 v[60:63], a[48:51], v[44:47], 0
  v_cndmask_b32 v68, v68, v64, s[46:47]
  v_mfma_f32_16x16x32_bf16 v[60:63], a[52:55], v[48:51], v[60:63]
  v_cndmask_b32 v69, v69, v65, s[46:47]
  v_mfma_f32_16x16x32_bf16 v[60:63], a[56:59], v[52:55], v[60:63]
  v_cndmask_b32 v70, v70, v66, s[46:47]
  v_mfma_f32_16x16x32_bf16 v[60:63], a[60:63], v[56:59], v[60:63]
  v_cndmask_b32 v71, v71, v67, s[46:47]
  s_lshl_b64 s[46:47], s[46:47], 1
  v_mfma_f32_16x16x32_bf16 v[64:67], a[64:67], v[44:47], 0
  v_cndmask_b32 v68, v68, v72, s[46:47]
  v_mfma_f32_16x16x32_bf16 v[64:67], a[68:71], v[48:51], v[64:67]
  v_cndmask_b32 v69, v69, v73, s[46:47]
  v_mfma_f32_16x16x32_bf16 v[64:67], a[72:75], v[52:55], v[64:67]
  v_cndmask_b32 v70, v70, v74, s[46:47]
  v_mfma_f32_16x16x32_bf16 v[64:67], a[76:79], v[56:59], v[64:67]
  v_cndmask_b32 v71, v71, v75, s[46:47]
  s_lshl_b64 s[46:47], s[46:47], 1
  v_mfma_f32_16x16x32_bf16 v[72:75], a[80:83], v[44:47], 0
  v_cndmask_b32 v68, v68, v60, s[46:47]
  v_mfma_f32_16x16x32_bf16 v[72:75], a[84:87], v[48:51], v[72:75]
  v_cndmask_b32 v69, v69, v61, s[46:47]
  v_mfma_f32_16x16x32_bf16 v[72:75], a[88:91], v[52:55], v[72:75]
  v_cndmask_b32 v70, v70, v62, s[46:47]
  v_mfma_f32_16x16x32_bf16 v[72:75], a[92:95], v[56:59], v[72:75]
  v_cndmask_b32 v71, v71, v63, s[46:47]
  s_lshl_b64 s[46:47], s[46:47], 1
  v_mfma_f32_16x16x32_bf16 v[60:63], a[96:99], v[44:47], 0
  v_cndmask_b32 v68, v68, v64, s[46:47]
  v_mfma_f32_16x16x32_bf16 v[60:63], a[100:103], v[48:51], v[60:63]
  v_cndmask_b32 v69, v69, v65, s[46:47]
  v_mfma_f32_16x16x32_bf16 v[60:63], a[104:107], v[52:55], v[60:63]
  v_cndmask_b32 v70, v70, v66, s[46:47]
  v_mfma_f32_16x16x32_bf16 v[60:63], a[108:111], v[56:59], v[60:63]
  v_cndmask_b32 v71, v71, v67, s[46:47]
  s_lshl_b64 s[46:47], s[46:47], 1
  v_mfma_f32_16x16x32_bf16 v[64:67], a[112:115], v[44:47], 0
  v_cndmask_b32 v68, v68, v72, s[46:47]
  v_mfma_f32_16x16x32_bf16 v[64:67], a[116:119], v[48:51], v[64:67]
  v_cndmask_b32 v69, v69, v73, s[46:47]
  v_mfma_f32_16x16x32_bf16 v[64:67], a[120:123], v[52:55], v[64:67]
  v_cndmask_b32 v70, v70, v74, s[46:47]
  v_mfma_f32_16x16x32_bf16 v[64:67], a[124:127], v[56:59], v[64:67]
  v_cndmask_b32 v71, v71, v75, s[46:47]
  s_lshl_b64 s[46:47], s[46:47], 1
  v_mfma_f32_16x16x32_bf16 v[72:75], a[128:131], v[44:47], 0
  v_cndmask_b32 v68, v68, v60, s[46:47]
  v_mfma_f32_16x16x32_bf16 v[72:75], a[132:135], v[48:51], v[72:75]
  v_cndmask_b32 v69, v69, v61, s[46:47]
  v_mfma_f32_16x16x32_bf16 v[72:75], a[136:139], v[52:55], v[72:75]
  v_cndmask_b32 v70, v70, v62, s[46:47]
  v_mfma_f32_16x16x32_bf16 v[72:75], a[140:143], v[56:59], v[72:75]
  v_cndmask_b32 v71, v71, v63, s[46:47]
  s_lshl_b64 s[46:47], s[46:47], 1
  v_mfma_f32_16x16x32_bf16 v[60:63], a[144:147], v[44:47], 0
  v_cndmask_b32 v68, v68, v64, s[46:47]
  v_mfma_f32_16x16x32_bf16 v[60:63], a[148:151], v[48:51], v[60:63]
  v_cndmask_b32 v69, v69, v65, s[46:47]
  v_mfma_f32_16x16x32_bf16 v[60:63], a[152:155], v[52:55], v[60:63]
  v_cndmask_b32 v70, v70, v66, s[46:47]
  v_mfma_f32_16x16x32_bf16 v[60:63], a[156:159], v[56:59], v[60:63]
  v_cndmask_b32 v71, v71, v67, s[46:47]
  s_lshl_b64 s[46:47], s[46:47], 1
  v_mfma_f32_16x16x32_bf16 v[64:67], a[160:163], v[44:47], 0
  v_cndmask_b32 v68, v68, v72, s[46:47]
  v_mfma_f32_16x16x32_bf16 v[64:67], a[164:167], v[48:51], v[64:67]
  v_cndmask_b32 v69, v69, v73, s[46:47]
  v_mfma_f32_16x16x32_bf16 v[64:67], a[168:171], v[52:55], v[64:67]
  v_cndmask_b32 v70, v70, v74, s[46:47]
  v_mfma_f32_16x16x32_bf16 v[64:67], a[172:175], v[56:59], v[64:67]
  v_cndmask_b32 v71, v71, v75, s[46:47]
  s_lshl_b64 s[46:47], s[46:47], 1
  v_mfma_f32_16x16x32_bf16 v[72:75], a[176:179], v[44:47], 0
  v_cndmask_b32 v68, v68, v60, s[46:47]
  v_mfma_f32_16x16x32_bf16 v[72:75], a[180:183], v[48:51], v[72:75]
  v_cndmask_b32 v69, v69, v61, s[46:47]
  v_mfma_f32_16x16x32_bf16 v[72:75], a[184:187], v[52:55], v[72:75]
  v_cndmask_b32 v70, v70, v62, s[46:47]
  v_mfma_f32_16x16x32_bf16 v[72:75], a[188:191], v[56:59], v[72:75]
  v_cndmask_b32 v71, v71, v63, s[46:47]
  s_lshl_b64 s[46:47], s[46:47], 1
  v_mfma_f32_16x16x32_bf16 v[60:63], a[192:195], v[44:47], 0
  v_cndmask_b32 v68, v68, v64, s[46:47]
  v_mfma_f32_16x16x32_bf16 v[60:63], a[196:199], v[48:51], v[60:63]
  v_cndmask_b32 v69, v69, v65, s[46:47]
  v_mfma_f32_16x16x32_bf16 v[60:63], a[200:203], v[52:55], v[60:63]
  v_cndmask_b32 v70, v70, v66, s[46:47]
  v_mfma_f32_16x16x32_bf16 v[60:63], a[204:207], v[56:59], v[60:63]
  v_cndmask_b32 v71, v71, v67, s[46:47]
  s_lshl_b64 s[46:47], s[46:47], 1
  v_mfma_f32_16x16x32_bf16 v[64:67], a[208:211], v[44:47], 0
  v_cndmask_b32 v68, v68, v72, s[46:47]
  v_mfma_f32_16x16x32_bf16 v[64:67], a[212:215], v[48:51], v[64:67]
  v_cndmask_b32 v69, v69, v73, s[46:47]
  v_mfma_f32_16x16x32_bf16 v[64:67], a[216:219], v[52:55], v[64:67]
  v_cndmask_b32 v70, v70, v74, s[46:47]
  v_mfma_f32_16x16x32_bf16 v[64:67], a[220:223], v[56:59], v[64:67]
  v_cndmask_b32 v71, v71, v75, s[46:47]
  s_lshl_b64 s[46:47], s[46:47], 1
  v_mfma_f32_16x16x32_bf16 v[72:75], a[224:227], v[44:47], 0
  v_cndmask_b32 v68, v68, v60, s[46:47]
  v_mfma_f32_16x16x32_bf16 v[72:75], a[228:231], v[48:51], v[72:75]
  v_cndmask_b32 v69, v69, v61, s[46:47]
  v_mfma_f32_16x16x32_bf16 v[72:75], a[232:235], v[52:55], v[72:75]
  v_cndmask_b32 v70, v70, v62, s[46:47]
  v_mfma_f32_16x16x32_bf16 v[72:75], a[236:239], v[56:59], v[72:75]
  v_cndmask_b32 v71, v71, v63, s[46:47]
  s_lshl_b64 s[46:47], s[46:47], 1
  v_mfma_f32_16x16x32_bf16 v[60:63], a[240:243], v[44:47], 0
  v_cndmask_b32 v68, v68, v64, s[46:47]
  v_mfma_f32_16x16x32_bf16 v[60:63], a[244:247], v[48:51], v[60:63]
  v_cndmask_b32 v69, v69, v65, s[46:47]
  v_mfma_f32_16x16x32_bf16 v[60:63], a[248:251], v[52:55], v[60:63]
  v_cndmask_b32 v70, v70, v66, s[46:47]
  v_mfma_f32_16x16x32_bf16 v[60:63], a[252:255], v[56:59], v[60:63]
  v_cndmask_b32 v71, v71, v67, s[46:47]
  s_lshl_b64 s[46:47], s[46:47], 1
  v_cndmask_b32 v68, v68, v72, s[46:47]
  v_cndmask_b32 v69, v69, v73, s[46:47]
  v_cndmask_b32 v70, v70, v74, s[46:47]
  v_cndmask_b32 v71, v71, v75, s[46:47]
  s_lshl_b64 s[46:47], s[46:47], 1
  s_nop 0
  v_cndmask_b32 v68, v68, v60, s[46:47]
  v_cndmask_b32 v69, v69, v61, s[46:47]
  v_cndmask_b32 v70, v70, v62, s[46:47]
  v_cndmask_b32 v71, v71, v63, s[46:47]
  s_lshl_b64 s[46:47], s[46:47], 1
  s_waitcnt vmcnt(31)
  ds_read_b128 v[12:15], v83 offset:12288
  s_waitcnt vmcnt(26)
  ds_read_b128 v[16:19], v83 offset:13312
  ds_read_b128 v[20:23], v83 offset:14336
  s_waitcnt vmcnt(19)
  ds_read_b128 v[24:27], v83 offset:15360
  v_max3_f32 v80, v68, v69, v70
  v_max_f32 v80, v80, v71
  s_nop 1
  v_max_f32_dpp v80, v80, v80 quad_perm:[1,0,3,2] row_mask:0xf bank_mask:0xf
  s_nop 1
  v_max_f32_dpp v80, v80, v80 quad_perm:[2,3,0,1] row_mask:0xf bank_mask:0xf
  s_nop 1
  v_max_f32_dpp v80, v80, v80 row_half_mirror row_mask:0xf bank_mask:0xf
  s_nop 1
  v_max_f32_dpp v80, v80, v80 row_mirror row_mask:0xf bank_mask:0xf
  v_mov_b32 v81, v80
  s_nop 1
  v_permlane16_swap_b32 v80, v81
  v_max_f32 v80, v80, v81
  v_mov_b32 v81, v80
  s_nop 1
  v_permlane32_swap_b32 v80, v81
  v_max_f32 v80, v80, v81
  v_mul_f32 v80, s50, v80
  v_fma_f32 v68, v68, s50, -v80
  v_fma_f32 v69, v69, s50, -v80
  v_fma_f32 v70, v70, s50, -v80
  v_fma_f32 v71, v71, s50, -v80
  v_exp_f32 v68, v68
  v_exp_f32 v69, v69
  v_exp_f32 v70, v70
  v_exp_f32 v71, v71
  v_cvt_pk_bf16_f32 v72, v68, v68
  v_cvt_pk_bf16_f32 v73, v69, v69
  v_cvt_pk_bf16_f32 v74, v70, v70
  v_cvt_pk_bf16_f32 v75, v71, v71
  ds_write_b128 v82, v[72:75]
  ds_read_b128 v[48:51], v2 offset:0
  ds_read_b128 v[52:55], v2 offset:32
  v_add_f32 v81, v68, v69
  v_add_f32 v82, v70, v71
  v_add_f32 v81, v81, v82
  s_nop 1
  v_add_f32_dpp v81, v81, v81 quad_perm:[1,0,3,2] row_mask:0xf bank_mask:0xf
  s_nop 1
  v_add_f32_dpp v81, v81, v81 quad_perm:[2,3,0,1] row_mask:0xf bank_mask:0xf
  s_nop 1
  v_add_f32_dpp v81, v81, v81 row_half_mirror row_mask:0xf bank_mask:0xf
  s_nop 1
  v_add_f32_dpp v81, v81, v81 row_mirror row_mask:0xf bank_mask:0xf
  v_mov_b32 v82, v81
  s_nop 1
  v_permlane16_swap_b32 v81, v82
  v_add_f32 v81, v81, v82
  v_mov_b32 v82, v81
  s_nop 1
  v_permlane32_swap_b32 v81, v82
  v_add_f32 v81, v81, v82
  s_lshl_b32 s36, s34, 10
  s_add_u32 s36, s36, 0
  v_add_u32 v68, s36, v1
  s_lshl_b32 s36, s55, 10
  s_add_u32 s36, s36, 524288
  v_add_u32 v69, s36, v1
  s_mov_b32 s46, 0xff00ff00
  s_mov_b32 s47, 0xff00ff00
  s_waitcnt lgkmcnt(1)
  v_and_b32 v60, v48, v4
  v_and_b32 v61, v48, v5
  v_and_b32 v62, v48, v6
  v_and_b32 v63, v48, v7
  v_and_b32 v64, v49, v4
  v_and_b32 v65, v49, v5
  v_and_b32 v66, v49, v6
  v_mfma_f32_16x16x32_bf16 v[76:79], v[12:15], v[60:63], 0
  ds_read_b128 v[12:15], v83 offset:16384
  v_and_b32 v67, v49, v7
  v_mfma_f32_16x16x32_bf16 v[44:47], v[92:95], v[60:63], 0
  v_and_b32 v60, v50, v4
  v_and_b32 v61, v50, v5
  v_and_b32 v62, v50, v6
  v_mfma_f32_16x16x32_bf16 v[76:79], v[84:87], v[64:67], v[76:79]
  v_and_b32 v63, v50, v7
  v_mfma_f32_16x16x32_bf16 v[44:47], v[16:19], v[64:67], v[44:47]
  s_waitcnt vmcnt(16)
  ds_read_b128 v[16:19], v83 offset:17408
  v_and_b32 v64, v51, v4
  v_and_b32 v65, v51, v5
  v_and_b32 v66, v51, v6
  v_mfma_f32_16x16x32_bf16 v[76:79], v[88:91], v[60:63], v[76:79]
  v_and_b32 v67, v51, v7
  ds_read_b128 v[48:51], v2 offset:64
  v_mfma_f32_16x16x32_bf16 v[44:47], v[96:99], v[60:63], v[44:47]
  s_waitcnt lgkmcnt(3)
  v_and_b32 v60, v52, v4
  v_and_b32 v61, v52, v5
  v_and_b32 v62, v52, v6
  v_mfma_f32_16x16x32_bf16 v[76:79], v[20:23], v[64:67], v[76:79]
  s_waitcnt vmcnt(14)
  ds_read_b128 v[20:23], v83 offset:18432
  v_and_b32 v63, v52, v7
  v_mfma_f32_16x16x32_bf16 v[44:47], v[100:103], v[64:67], v[44:47]
  s_cmp_lg_u32 s35, 0
  s_cbranch_scc1 Lpv8
  global_load_dwordx4 v[168:171], v1, s[8:9] offset:0 nt
  global_load_dwordx4 v[172:175], v1, s[8:9] offset:1024 nt
  s_add_u32 m0, s51, 22528
  s_nop 0
  global_load_lds_dwordx4 v1, s[8:9] offset:2048 nt
  global_load_dwordx4 v[176:179], v1, s[8:9] offset:3072 nt
  s_add_u32 s8, s8, 65536
  s_addc_u32 s9, s9, 0
  s_add_u32 m0, s51, 23552
  s_nop 0
  global_load_lds_dwordx4 v1, s[8:9] offset:0 nt
  global_load_dwordx4 v[180:183], v1, s[8:9] offset:1024 nt
  global_load_dwordx4 v[184:187], v1, s[8:9] offset:2048 nt
  s_add_u32 m0, s51, 22528
  s_nop 0
  global_load_lds_dwordx4 v1, s[8:9] offset:3072 nt
  s_add_u32 s8, s8, 65536
  s_addc_u32 s9, s9, 0
Lpv8:
  v_and_b32 v64, v53, v4
  v_and_b32 v65, v53, v5
  v_and_b32 v66, v53, v6
  v_mfma_f32_16x16x32_bf16 v[76:79], v[104:107], v[60:63], v[76:79]
  v_and_b32 v67, v53, v7
  v_mfma_f32_16x16x32_bf16 v[44:47], v[24:27], v[60:63], v[44:47]
  s_waitcnt vmcnt(17)
  ds_read_b128 v[24:27], v83 offset:19456
  v_and_b32 v60, v54, v4
  v_and_b32 v61, v54, v5
  v_and_b32 v62, v54, v6
  v_mfma_f32_16x16x32_bf16 v[76:79], v[108:111], v[64:67], v[76:79]
  v_and_b32 v63, v54, v7
  v_mfma_f32_16x16x32_bf16 v[44:47], v[116:119], v[64:67], v[44:47]
  v_and_b32 v64, v55, v4
  v_and_b32 v65, v55, v5
  v_and_b32 v66, v55, v6
  s_waitcnt lgkmcnt(4)
  v_mfma_f32_16x16x32_bf16 v[76:79], v[12:15], v[60:63], v[76:79]
  s_waitcnt vmcnt(15)
  ds_read_b128 v[12:15], v83 offset:20480
  v_and_b32 v67, v55, v7
  ds_read_b128 v[52:55], v2 offset:96
  v_mfma_f32_16x16x32_bf16 v[44:47], v[120:123], v[60:63], v[44:47]
  s_waitcnt lgkmcnt(4)
  v_and_b32 v60, v48, v4
  v_and_b32 v61, v48, v5
  v_and_b32 v62, v48, v6
  v_mfma_f32_16x16x32_bf16 v[76:79], v[112:115], v[64:67], v[76:79]
  v_and_b32 v63, v48, v7
  v_mfma_f32_16x16x32_bf16 v[44:47], v[16:19], v[64:67], v[44:47]
  s_waitcnt vmcnt(10)
  ds_read_b128 v[16:19], v83 offset:21504
  s_cmp_lg_u32 s35, 0
  s_cbranch_scc1 Lpv16
  global_load_dwordx4 v[188:191], v1, s[8:9] offset:0 nt
  s_add_u32 m0, s51, 25600
  s_nop 0
  global_load_lds_dwordx4 v1, s[8:9] offset:1024 nt
  global_load_dwordx4 v[192:195], v1, s[8:9] offset:2048 nt
  global_load_dwordx4 v[196:199], v1, s[8:9] offset:3072 nt
  s_add_u32 s8, s8, 65536
  s_addc_u32 s9, s9, 0
  global_load_dwordx4 v[200:203], v1, s[8:9] offset:0 nt
  global_load_dwordx4 v[204:207], v1, s[8:9] offset:1024 nt
  s_add_u32 m0, s51, 25600
  s_nop 0
  global_load_lds_dwordx4 v1, s[8:9] offset:2048 nt
  global_load_dwordx4 v[208:211], v1, s[8:9] offset:3072 nt
  s_add_u32 s8, s8, 65536
  s_addc_u32 s9, s9, 0
Lpv16:
  v_and_b32 v64, v49, v4
  v_and_b32 v65, v49, v5
  v_and_b32 v66, v49, v6
  v_mfma_f32_16x16x32_bf16 v[76:79], v[124:127], v[60:63], v[76:79]
  v_and_b32 v67, v49, v7
  v_mfma_f32_16x16x32_bf16 v[44:47], v[136:139], v[60:63], v[44:47]
  v_and_b32 v60, v50, v4
  v_and_b32 v61, v50, v5
  v_and_b32 v62, v50, v6
  s_waitcnt lgkmcnt(4)
  v_mfma_f32_16x16x32_bf16 v[76:79], v[20:23], v[64:67], v[76:79]
  ds_read_b128 v[20:23], v83 offset:22528
  v_and_b32 v63, v50, v7
  v_mfma_f32_16x16x32_bf16 v[44:47], v[140:143], v[64:67], v[44:47]
  v_and_b32 v64, v51, v4
  v_and_b32 v65, v51, v5
  v_and_b32 v66, v51, v6
  v_mfma_f32_16x16x32_bf16 v[76:79], v[128:131], v[60:63], v[76:79]
  v_and_b32 v67, v51, v7
  ds_read_b128 v[48:51], v2 offset:128
  s_waitcnt lgkmcnt(5)
  v_mfma_f32_16x16x32_bf16 v[44:47], v[24:27], v[60:63], v[44:47]
  s_waitcnt vmcnt(11)
  ds_read_b128 v[24:27], v83 offset:23552
  s_waitcnt lgkmcnt(4)
  v_and_b32 v60, v52, v4
  v_and_b32 v61, v52, v5
  v_and_b32 v62, v52, v6
  v_mfma_f32_16x16x32_bf16 v[76:79], v[132:135], v[64:67], v[76:79]
  v_and_b32 v63, v52, v7
  v_mfma_f32_16x16x32_bf16 v[44:47], v[144:147], v[64:67], v[44:47]
  s_cmp_lg_u32 s35, 0
  s_cbranch_scc1 Lpv24
  s_add_u32 m0, s51, 28672
  s_nop 0
  global_load_lds_dwordx4 v1, s[8:9] offset:0 nt
  global_load_dwordx4 v[212:215], v1, s[8:9] offset:1024 nt
  global_load_dwordx4 v[216:219], v1, s[8:9] offset:2048 nt
  s_add_u32 m0, s51, 27648
  s_nop 0
  global_load_lds_dwordx4 v1, s[8:9] offset:3072 nt
  s_add_u32 s8, s8, 65536
  s_addc_u32 s9, s9, 0
  global_load_dwordx4 v[220:223], v1, s[8:9] offset:0 nt
  s_add_u32 m0, s51, 28672
  s_nop 0
  global_load_lds_dwordx4 v1, s[8:9] offset:1024 nt
  global_load_dwordx4 v[224:227], v1, s[8:9] offset:2048 nt
  global_load_dwordx4 v[228:231], v1, s[8:9] offset:3072 nt
  s_add_u32 s8, s8, 65536
  s_addc_u32 s9, s9, 0
Lpv24:
  v_and_b32 v64, v53, v4
  v_and_b32 v65, v53, v5
  v_and_b32 v66, v53, v6
  v_mfma_f32_16x16x32_bf16 v[76:79], v[12:15], v[60:63], v[76:79]
  ds_read_b128 v[12:15], v83 offset:24576
  v_and_b32 v67, v53, v7
  v_mfma_f32_16x16x32_bf16 v[44:47], v[156:159], v[60:63], v[44:47]
  v_and_b32 v60, v54, v4
  v_and_b32 v61, v54, v5
  v_and_b32 v62, v54, v6
  v_mfma_f32_16x16x32_bf16 v[76:79], v[148:151], v[64:67], v[76:79]
  v_and_b32 v63, v54, v7
  s_waitcnt lgkmcnt(4)
  v_mfma_f32_16x16x32_bf16 v[44:47], v[16:19], v[64:67], v[44:47]
  s_waitcnt vmcnt(16)
  ds_read_b128 v[16:19], v83 offset:25600
  v_and_b32 v64, v55, v4
  v_and_b32 v65, v55, v5
  v_and_b32 v66, v55, v6
  v_mfma_f32_16x16x32_bf16 v[76:79], v[152:155], v[60:63], v[76:79]
  v_and_b32 v67, v55, v7
  ds_read_b128 v[52:55], v2 offset:160
  v_mfma_f32_16x16x32_bf16 v[44:47], v[160:163], v[60:63], v[44:47]
  s_waitcnt lgkmcnt(4)
  v_and_b32 v60, v48, v4
  v_and_b32 v61, v48, v5
  v_and_b32 v62, v48, v6
  v_mfma_f32_16x16x32_bf16 v[76:79], v[20:23], v[64:67], v[76:79]
  s_waitcnt vmcnt(14)
  ds_read_b128 v[20:23], v83 offset:26624
  v_and_b32 v63, v48, v7
  v_mfma_f32_16x16x32_bf16 v[44:47], v[164:167], v[64:67], v[44:47]
  s_cmp_lg_u32 s35, 0
  s_cbranch_scc1 Lpv32
  global_load_dwordx4 v[232:235], v1, s[8:9] offset:0 nt
  global_load_dwordx4 v[236:239], v1, s[8:9] offset:1024 nt
  s_add_u32 m0, s51, 30720
  s_nop 0
  global_load_lds_dwordx4 v1, s[8:9] offset:2048 nt
  global_load_dwordx4 v[240:243], v1, s[8:9] offset:3072 nt
  s_add_u32 s8, s8, 65536
  s_addc_u32 s9, s9, 0
  s_add_u32 m0, s51, 31744
  s_nop 0
  global_load_lds_dwordx4 v1, s[8:9] offset:0 nt
  global_load_dwordx4 v[244:247], v1, s[8:9] offset:1024 nt
  global_load_dwordx4 v[248:251], v1, s[8:9] offset:2048 nt
  global_load_dwordx4 v[252:255], v1, s[8:9] offset:3072 nt
  s_add_u32 s8, s8, 65536
  s_addc_u32 s9, s9, 0
  v_mov_b32 v71, v2
  s_lshl_b32 s36, s32, 2
  s_add_u32 s36, s36, s34
  s_lshl_b32 s36, s36, 8
  s_add_u32 s36, s36, s33
  s_lshl_b32 s36, s36, 7
  v_lshrrev_b32 v70, 3, v0
  v_lshlrev_b32 v70, 10, v70
  v_and_b32 v2, 0x70, v1
  v_add3_u32 v70, v70, v2, s36
  global_load_dwordx4 v[28:31], v70, s[12:13]
  v_add_u32 v70, 8192, v70
  global_load_dwordx4 v[32:35], v70, s[12:13]
  v_add_u32 v70, 8192, v70
  global_load_dwordx4 v[36:39], v70, s[12:13]
  v_add_u32 v70, 8192, v70
  global_load_dwordx4 v[40:43], v70, s[12:13]
  v_mov_b32 v2, v71
  v_lshrrev_b32 v71, 4, v0
  v_lshlrev_b32 v70, 5, v71
  v_xor_b32 v70, v70, v1
  v_and_b32 v70, 0xf0, v70
  v_lshl_add_u32 v70, v71, 10, v70
  s_sub_u32 s36, 0, s34
  s_and_b32 s36, s36, 3
  s_lshl_b32 s36, s36, 12
  s_add_u32 s36, s36, s63
  s_add_u32 m0, s36, 0
  v_xor_b32 v71, 0, v70
  global_load_lds_dwordx4 v71, s[16:17] nt
  s_add_u32 s16, s16, 4096
  s_addc_u32 s17, s17, 0
  s_add_u32 m0, s36, 1024
  v_xor_b32 v71, 128, v70
  global_load_lds_dwordx4 v71, s[16:17] nt
  s_add_u32 s16, s16, 4096
  s_addc_u32 s17, s17, 0
  s_add_u32 m0, s36, 2048
  v_xor_b32 v71, 16, v70
  global_load_lds_dwordx4 v71, s[16:17] nt
  s_add_u32 s16, s16, 4096
  s_addc_u32 s17, s17, 0
  s_add_u32 m0, s36, 3072
  v_xor_b32 v71, 144, v70
  global_load_lds_dwordx4 v71, s[16:17] nt
  s_add_u32 s16, s16, 4096
  s_addc_u32 s17, s17, 0
  s_sub_u32 s36, 1, s34
  s_and_b32 s36, s36, 3
  s_lshl_b32 s36, s36, 12
  s_add_u32 s36, s36, s63
  s_add_u32 m0, s36, 0
  v_xor_b32 v71, 0, v70
  global_load_lds_dwordx4 v71, s[16:17] nt
  s_add_u32 s16, s16, 4096
  s_addc_u32 s17, s17, 0
  s_add_u32 m0, s36, 1024
  v_xor_b32 v71, 128, v70
  global_load_lds_dwordx4 v71, s[16:17] nt
  s_add_u32 s16, s16, 4096
  s_addc_u32 s17, s17, 0
  s_add_u32 m0, s36, 2048
  v_xor_b32 v71, 16, v70
  global_load_lds_dwordx4 v71, s[16:17] nt
  s_add_u32 s16, s16, 4096
  s_addc_u32 s17, s17, 0
  s_add_u32 m0, s36, 3072
  v_xor_b32 v71, 144, v70
  global_load_lds_dwordx4 v71, s[16:17] nt
  s_add_u32 s16, s16, 4096
  s_addc_u32 s17, s17, 0
Lpv32:
  v_and_b32 v64, v49, v4
  v_and_b32 v65, v49, v5
  v_and_b32 v66, v49, v6
  v_mfma_f32_16x16x32_bf16 v[76:79], v[168:171], v[60:63], v[76:79]
  v_and_b32 v67, v49, v7
  s_waitcnt lgkmcnt(4)
  v_mfma_f32_16x16x32_bf16 v[44:47], v[24:27], v[60:63], v[44:47]
  s_waitcnt vmcnt(29)
  ds_read_b128 v[24:27], v83 offset:27648
  v_and_b32 v60, v50, v4
  v_and_b32 v61, v50, v5
  v_and_b32 v62, v50, v6
  v_mfma_f32_16x16x32_bf16 v[76:79], v[172:175], v[64:67], v[76:79]
  v_and_b32 v63, v50, v7
  v_mfma_f32_16x16x32_bf16 v[44:47], v[180:183], v[64:67], v[44:47]
  v_and_b32 v64, v51, v4
  v_and_b32 v65, v51, v5
  v_and_b32 v66, v51, v6
  s_waitcnt lgkmcnt(4)
  v_mfma_f32_16x16x32_bf16 v[76:79], v[12:15], v[60:63], v[76:79]
  s_waitcnt vmcnt(27)
  ds_read_b128 v[12:15], v83 offset:28672
  v_and_b32 v67, v51, v7
  ds_read_b128 v[48:51], v2 offset:192
  v_mfma_f32_16x16x32_bf16 v[44:47], v[184:187], v[60:63], v[44:47]
  s_waitcnt lgkmcnt(4)
  v_and_b32 v60, v52, v4
  v_and_b32 v61, v52, v5
  v_and_b32 v62, v52, v6
  v_mfma_f32_16x16x32_bf16 v[76:79], v[176:179], v[64:67], v[76:79]
  v_and_b32 v63, v52, v7
  v_mfma_f32_16x16x32_bf16 v[44:47], v[16:19], v[64:67], v[44:47]
  s_waitcnt vmcnt(22)
  ds_read_b128 v[16:19], v83 offset:29696
  v_and_b32 v64, v53, v4
  v_and_b32 v65, v53, v5
  v_and_b32 v66, v53, v6
  v_mfma_f32_16x16x32_bf16 v[76:79], v[188:191], v[60:63], v[76:79]
  v_and_b32 v67, v53, v7
  v_mfma_f32_16x16x32_bf16 v[44:47], v[200:203], v[60:63], v[44:47]
  v_and_b32 v60, v54, v4
  v_and_b32 v61, v54, v5
  v_and_b32 v62, v54, v6
  s_waitcnt lgkmcnt(4)
  v_mfma_f32_16x16x32_bf16 v[76:79], v[20:23], v[64:67], v[76:79]
  ds_read_b128 v[20:23], v83 offset:30720
  v_and_b32 v63, v54, v7
  v_mfma_f32_16x16x32_bf16 v[44:47], v[204:207], v[64:67], v[44:47]
  v_and_b32 v64, v55, v4
  v_and_b32 v65, v55, v5
  v_and_b32 v66, v55, v6
  v_mfma_f32_16x16x32_bf16 v[76:79], v[192:195], v[60:63], v[76:79]
  v_and_b32 v67, v55, v7
  ds_read_b128 v[52:55], v2 offset:224
  s_waitcnt lgkmcnt(5)
  v_mfma_f32_16x16x32_bf16 v[44:47], v[24:27], v[60:63], v[44:47]
  s_waitcnt vmcnt(15)
  ds_read_b128 v[24:27], v83 offset:31744
  s_waitcnt lgkmcnt(4)
  v_and_b32 v60, v48, v4
  v_and_b32 v61, v48, v5
  v_and_b32 v62, v48, v6
  v_mfma_f32_16x16x32_bf16 v[76:79], v[196:199], v[64:67], v[76:79]
  v_and_b32 v63, v48, v7
  v_mfma_f32_16x16x32_bf16 v[44:47], v[208:211], v[64:67], v[44:47]
  v_and_b32 v64, v49, v4
  v_and_b32 v65, v49, v5
  v_and_b32 v66, v49, v6
  v_mfma_f32_16x16x32_bf16 v[76:79], v[12:15], v[60:63], v[76:79]
  ds_read_b128 v[12:15], v83 offset:32768
  v_and_b32 v67, v49, v7
  v_mfma_f32_16x16x32_bf16 v[44:47], v[220:223], v[60:63], v[44:47]
  v_and_b32 v60, v50, v4
  v_and_b32 v61, v50, v5
  v_and_b32 v62, v50, v6
  v_mfma_f32_16x16x32_bf16 v[76:79], v[212:215], v[64:67], v[76:79]
  v_and_b32 v63, v50, v7
  s_waitcnt lgkmcnt(4)
  v_mfma_f32_16x16x32_bf16 v[44:47], v[16:19], v[64:67], v[44:47]
  v_and_b32 v64, v51, v4
  v_and_b32 v65, v51, v5
  v_and_b32 v66, v51, v6
  v_mfma_f32_16x16x32_bf16 v[76:79], v[216:219], v[60:63], v[76:79]
  v_and_b32 v67, v51, v7
  v_mfma_f32_16x16x32_bf16 v[44:47], v[224:227], v[60:63], v[44:47]
  s_waitcnt lgkmcnt(2)
  v_and_b32 v60, v52, v4
  v_and_b32 v61, v52, v5
  v_and_b32 v62, v52, v6
  v_mfma_f32_16x16x32_bf16 v[76:79], v[20:23], v[64:67], v[76:79]
  v_and_b32 v63, v52, v7
  v_mfma_f32_16x16x32_bf16 v[44:47], v[228:231], v[64:67], v[44:47]
  v_and_b32 v64, v53, v4
  v_and_b32 v65, v53, v5
  v_and_b32 v66, v53, v6
  v_mfma_f32_16x16x32_bf16 v[76:79], v[232:235], v[60:63], v[76:79]
  v_and_b32 v67, v53, v7
  s_waitcnt lgkmcnt(1)
  v_mfma_f32_16x16x32_bf16 v[44:47], v[24:27], v[60:63], v[44:47]
  v_and_b32 v60, v54, v4
  v_and_b32 v61, v54, v5
  v_and_b32 v62, v54, v6
  v_mfma_f32_16x16x32_bf16 v[76:79], v[236:239], v[64:67], v[76:79]
  v_and_b32 v63, v54, v7
  s_waitcnt vmcnt(14)
  v_mfma_f32_16x16x32_bf16 v[44:47], v[244:247], v[64:67], v[44:47]
  v_and_b32 v64, v55, v4
  v_and_b32 v65, v55, v5
  v_and_b32 v66, v55, v6
  s_waitcnt lgkmcnt(0)
  v_mfma_f32_16x16x32_bf16 v[76:79], v[12:15], v[60:63], v[76:79]
  v_and_b32 v67, v55, v7
  s_waitcnt vmcnt(13)
  v_mfma_f32_16x16x32_bf16 v[44:47], v[248:251], v[60:63], v[44:47]
  v_mfma_f32_16x16x32_bf16 v[76:79], v[240:243], v[64:67], v[76:79]
  s_waitcnt vmcnt(12)
  v_mfma_f32_16x16x32_bf16 v[44:47], v[252:255], v[64:67], v[44:47]
  v_lshrrev_b32 v70, 4, v0
  v_add_u32 v70, s38, v70
  v_lshlrev_b32 v70, 13, v70
  v_and_b32 v2, 0xf0, v1
  v_add3_u32 v70, v70, v2, s39
  global_load_dwordx4 v[12:15], v70, s[18:19]
  v_add_u32 v70, 65536, v70
  global_load_dwordx4 v[16:19], v70, s[18:19]
  v_add_u32 v70, 65536, v70
  global_load_dwordx4 v[20:23], v70, s[18:19]
  v_add_u32 v70, 65536, v70
  global_load_dwordx4 v[24:27], v70, s[18:19]
  s_lshl_b32 s36, s34, 3
  s_add_u32 s36, s36, 6912
  v_mov_b32 v2, s36
  v_cndmask_b32 v76, v76, v44, s[46:47]
  v_cndmask_b32 v77, v77, v45, s[46:47]
  v_cndmask_b32 v78, v78, v46, s[46:47]
  v_cndmask_b32 v79, v79, v47, s[46:47]
  ds_write_b64 v2, v[80:81]
  ds_write_b128 v68, v[76:79]
  s_waitcnt lgkmcnt(0)
  s_barrier
  s_cmp_eq_u32 s34, 0
  s_cbranch_scc0 LA1
  ds_read_b128 v[60:63], v2
  ds_read_b128 v[64:67], v2 offset:16
  ds_read_b128 v[44:47], v68 offset:0
  ds_read_b128 v[48:51], v68 offset:1024
  ds_read_b128 v[52:55], v68 offset:2048
  ds_read_b128 v[56:59], v68 offset:3072
  s_waitcnt lgkmcnt(4)
  v_max3_f32 v80, v60, v62, v64
  v_max_f32 v80, v80, v66
  v_sub_f32 v60, v60, v80
  v_sub_f32 v62, v62, v80
  v_sub_f32 v64, v64, v80
  v_sub_f32 v66, v66, v80
  v_exp_f32 v60, v60
  v_exp_f32 v62, v62
  v_exp_f32 v64, v64
  v_exp_f32 v66, v66
  v_mul_f32 v81, v60, v61
  v_fmac_f32 v81, v62, v63
  v_fmac_f32 v81, v64, v65
  v_fmac_f32 v81, v66, v67
  s_waitcnt lgkmcnt(0)
  v_mul_f32 v44, v60, v44
  v_mul_f32 v45, v60, v45
  v_mul_f32 v46, v60, v46
  v_mul_f32 v47, v60, v47
  v_fmac_f32 v44, v62, v48
  v_fmac_f32 v45, v62, v49
  v_fmac_f32 v46, v62, v50
  v_fmac_f32 v47, v62, v51
  v_fmac_f32 v44, v64, v52
  v_fmac_f32 v45, v64, v53
  v_fmac_f32 v46, v64, v54
  v_fmac_f32 v47, v64, v55
  v_fmac_f32 v44, v66, v56
  v_fmac_f32 v45, v66, v57
  v_fmac_f32 v46, v66, v58
  v_fmac_f32 v47, v66, v59
  v_add_f32_dpp v44, v44, v44 row_ror:8 row_mask:0xf bank_mask:0xf
  v_add_f32_dpp v45, v45, v45 row_ror:8 row_mask:0xf bank_mask:0xf
  v_add_f32_dpp v46, v46, v46 row_ror:8 row_mask:0xf bank_mask:0xf
  v_add_f32_dpp v47, v47, v47 row_ror:8 row_mask:0xf bank_mask:0xf
  v_cndmask_b32 v44, v44, v80, s[46:47]
  v_cndmask_b32 v45, v45, v81, s[46:47]
  s_cmp_eq_u32 s62, 0
  s_cbranch_scc1 Ls3
  global_store_dwordx4 v69, v[44:47], s[40:41]
  s_branch Ls3e
Ls3:
  global_store_dwordx4 v69, v[44:47], s[40:41] sc1
Ls3e:
LA1:
  s_lshl_b32 s36, s32, 13
  s_lshl_b32 s46, s34, 8
  s_add_u32 s36, s36, s46
  s_add_u32 s36, s36, 524288
  v_lshrrev_b32 v60, 3, v0
  v_lshlrev_b32 v60, 10, v60
  v_and_b32 v2, 0x70, v1
  v_add3_u32 v60, v60, v2, s36
  s_lshl_b32 s36, s34, 10
  s_add_u32 s36, s36, 8192
  v_lshlrev_b32 v74, 1, v0
  v_and_b32 v74, 0x70, v74
  v_add_u32 v74, s36, v74
  v_lshrrev_b32 v73, 1, v0
  v_and_b32 v73, 8, v73
  v_add3_u32 v73, v73, v2, s36
  v_and_b32 v2, 32, v0
  v_lshl_add_u32 v73, v2, 2, v73
  s_branch Lp3
Lp3r:
  s_sub_u32 s37, s37, 1
  s_cbranch_scc1 Lend
Lp3:
  global_load_dwordx4 v[44:47], v60, s[40:41] sc1
  global_load_dwordx4 v[48:51], v60, s[40:41] offset:128 sc1
  s_waitcnt vmcnt(0)
Lp3c:
  v_max3_u32 v64, v44, v45, v46
  v_max3_u32 v64, v64, v47, v48
  v_max3_u32 v64, v64, v49, v50
  v_max3_u32 v64, v64, v51, v51
  v_cmp_eq_u32 vcc, -1, v64
  s_cbranch_vccnz Lp3r
  s_cmp_lg_u32 s35, 0
  s_cbranch_scc1 LA2
  v_mov_b32 v68, -1
  v_mov_b32 v69, -1
  v_mov_b32 v70, -1
  v_mov_b32 v71, -1
  global_store_dwordx4 v1, v[68:71], s[64:65] offset:0 sc1
  global_store_dwordx4 v1, v[68:71], s[64:65] offset:1024 sc1
  global_store_dwordx4 v1, v[68:71], s[64:65] offset:2048 sc1
  global_store_dwordx4 v1, v[68:71], s[64:65] offset:3072 sc1
  v_lshrrev_b32 v65, 4, v0
  v_lshlrev_b32 v64, 5, v65
  v_xor_b32 v64, v64, v1
  v_and_b32 v64, 0xf0, v64
  v_lshl_add_u32 v64, v65, 10, v64
  s_sub_u32 s36, 2, s34
  s_and_b32 s36, s36, 3
  s_lshl_b32 s36, s36, 12
  s_add_u32 s36, s36, s63
  s_add_u32 m0, s36, 0
  v_xor_b32 v65, 0, v64
  global_load_lds_dwordx4 v65, s[16:17] nt
  s_add_u32 s16, s16, 4096
  s_addc_u32 s17, s17, 0
  s_add_u32 m0, s36, 1024
  v_xor_b32 v65, 128, v64
  global_load_lds_dwordx4 v65, s[16:17] nt
  s_add_u32 s16, s16, 4096
  s_addc_u32 s17, s17, 0
  s_add_u32 m0, s36, 2048
  v_xor_b32 v65, 16, v64
  global_load_lds_dwordx4 v65, s[16:17] nt
  s_add_u32 s16, s16, 4096
  s_addc_u32 s17, s17, 0
  s_add_u32 m0, s36, 3072
  v_xor_b32 v65, 144, v64
  global_load_lds_dwordx4 v65, s[16:17] nt
  s_add_u32 s16, s16, 4096
  s_addc_u32 s17, s17, 0
  s_sub_u32 s36, 3, s34
  s_and_b32 s36, s36, 3
  s_lshl_b32 s36, s36, 12
  s_add_u32 s36, s36, s63
  s_add_u32 m0, s36, 0
  v_xor_b32 v65, 0, v64
  global_load_lds_dwordx4 v65, s[16:17] nt
  s_add_u32 s16, s16, 4096
  s_addc_u32 s17, s17, 0
  s_add_u32 m0, s36, 1024
  v_xor_b32 v65, 128, v64
  global_load_lds_dwordx4 v65, s[16:17] nt
  s_add_u32 s16, s16, 4096
  s_addc_u32 s17, s17, 0
  s_add_u32 m0, s36, 2048
  v_xor_b32 v65, 16, v64
  global_load_lds_dwordx4 v65, s[16:17] nt
  s_add_u32 s16, s16, 4096
  s_addc_u32 s17, s17, 0
  s_add_u32 m0, s36, 3072
  v_xor_b32 v65, 144, v64
  global_load_lds_dwordx4 v65, s[16:17] nt
  s_add_u32 s16, s16, 4096
  s_addc_u32 s17, s17, 0
LA2:
  v_max_f32_dpp v50, v48, v48 row_ror:8 row_mask:0xf bank_mask:0xf
  v_mov_b32 v51, v50
  s_nop 1
  v_permlane16_swap_b32 v50, v51
  v_max_f32 v50, v50, v51
  v_sub_f32 v48, v48, v50
  v_exp_f32 v48, v48
  s_nop 0
  v_mul_f32 v49, v49, v48
  v_mul_f32 v50, v49, 1.0
  v_mul_f32 v44, v44, v48
  v_mul_f32 v45, v45, v48
  v_mul_f32 v46, v46, v48
  v_mul_f32 v47, v47, v48
  v_permlane16_swap_b32 v49, v50
  v_permlane16_swap_b32 v44, v46
  v_permlane16_swap_b32 v45, v47
  v_add_f32 v49, v49, v50
  v_add_f32 v44, v44, v46
  v_add_f32 v45, v45, v47
  v_add_f32_dpp v49, v49, v49 row_ror:8 row_mask:0xf bank_mask:0xf
  v_add_f32_dpp v44, v44, v44 row_ror:8 row_mask:0xf bank_mask:0xf
  v_add_f32_dpp v45, v45, v45 row_ror:8 row_mask:0xf bank_mask:0xf
  v_rcp_f32 v49, v49
  s_nop 0
  v_mul_f32 v44, v44, v49
  v_mul_f32 v45, v45, v49
  v_cvt_pk_bf16_f32 v44, v44, v44
  v_cvt_pk_bf16_f32 v45, v45, v45
  ds_write_b64 v73, v[44:45]
  s_branch LWO
LB:
  s_lshl_b32 s36, s55, 7
  s_add_u32 s36, s36, 917504
  v_and_b32 v68, 8, v0
  v_lshlrev_b32 v68, 12, v68
  v_and_b32 v2, 0x70, v1
  v_add3_u32 v68, v68, v2, s36
  s_lshl_b32 s36, s34, 4
  s_add_u32 s36, s36, 7168
  v_and_b32 v69, 1, v0
  v_lshlrev_b32 v69, 7, v69
  v_and_b32 v2, 32, v0
  v_lshl_add_u32 v69, v2, 1, v69
  v_lshrrev_b32 v2, 1, v0
  v_and_b32 v2, 8, v2
  v_add3_u32 v69, v69, v2, s36
  s_waitcnt lgkmcnt(3)
  v_mfma_f32_16x16x32_bf16 v[60:63], v[28:31], v[44:47], 0
  s_waitcnt lgkmcnt(2)
  v_mfma_f32_16x16x32_bf16 v[60:63], v[32:35], v[48:51], v[60:63]
  s_waitcnt lgkmcnt(1)
  v_mfma_f32_16x16x32_bf16 v[60:63], v[36:39], v[52:55], v[60:63]
  s_waitcnt lgkmcnt(0)
  v_mfma_f32_16x16x32_bf16 v[60:63], v[40:43], v[56:59], v[60:63]
  s_nop 7
  v_cvt_pk_bf16_f32 v60, v60, v61
  v_cvt_pk_bf16_f32 v61, v62, v63
  ds_write_b64 v69, v[60:61]
  s_waitcnt lgkmcnt(0)
  s_barrier
  s_cmp_eq_u32 s34, 0
  s_cbranch_scc0 LB3
  s_mov_b64 exec, 0xffff
  ds_read_b128 v[60:63], v1 offset:7168
  s_waitcnt lgkmcnt(0)
  global_store_dwordx4 v68, v[60:63], s[40:41] sc1
  s_mov_b64 exec, -1
LB3:
  s_lshr_b32 s46, s2, 6
  s_lshl_b32 s36, s46, 14
  s_lshl_b32 s47, s34, 8
  s_add_u32 s36, s36, s47
  s_add_u32 s36, s36, 917504
  v_and_b32 v76, 15, v0
  v_lshrrev_b32 v80, 2, v0
  v_lshlrev_b32 v80, 10, v80
  v_and_b32 v2, 48, v1
  v_add3_u32 v80, v80, v2, s36
  v_lshlrev_b32 v2, 1, v0
  v_and_b32 v2, 0x60, v2
  s_lshl_b32 s36, s34, 14
  s_add_u32 s36, s36, 98304
  v_lshlrev_b32 v81, 5, v0
  v_and_b32 v81, 0xe0, v81
  v_xor_b32 v81, v81, v2
  v_lshlrev_b32 v2, 1, v0
  v_and_b32 v2, 16, v2
  v_or_b32 v81, v81, v2
  v_lshlrev_b32 v2, 8, v76
  v_add3_u32 v81, v81, v2, s36
  v_lshrrev_b32 v76, 2, v0
  v_lshlrev_b32 v82, 5, v76
  v_and_b32 v82, 0xe0, v82
  v_lshrrev_b32 v2, 1, v0
  v_and_b32 v2, 16, v2
  v_or_b32 v82, v82, v2
  v_lshlrev_b32 v2, 3, v0
  v_and_b32 v2, 24, v2
  v_xor_b32 v82, v82, v2
  v_lshlrev_b32 v2, 8, v76
  v_add3_u32 v82, v82, v2, s36
  s_barrier
  ds_read_b128 v[28:31], v81 offset:0
  ds_read_b128 v[32:35], v81 offset:4096
  ds_read_b128 v[36:39], v81 offset:8192
  ds_read_b128 v[40:43], v81 offset:12288
  s_sleep 12
  s_branch Lp4
Lp4r:
  s_sub_u32 s37, s37, 1
  s_cbranch_scc1 Lend
Lp4:
  global_load_dwordx4 v[44:47], v80, s[40:41] offset:0 sc1
  global_load_dwordx4 v[48:51], v80, s[40:41] offset:64 sc1
  global_load_dwordx4 v[52:55], v80, s[40:41] offset:128 sc1
  global_load_dwordx4 v[56:59], v80, s[40:41] offset:192 sc1
  s_waitcnt vmcnt(0)
Lp4c:
  v_max3_u32 v83, v44, v45, v46
  v_max3_u32 v83, v83, v47, v48
  v_max3_u32 v83, v83, v49, v50
  v_max3_u32 v83, v83, v51, v52
  v_max3_u32 v83, v83, v53, v54
  v_max3_u32 v83, v83, v55, v56
  v_max3_u32 v83, v83, v57, v58
  v_max3_u32 v83, v83, v59, v59
  v_cmp_eq_u32 vcc, -1, v83
  s_cbranch_vccnz Lp4r
  ds_write_b128 v78, v[44:47]
  ds_read_b128 v[44:47], v79
  ds_write_b128 v78, v[48:51]
  ds_read_b128 v[48:51], v79
  ds_write_b128 v78, v[52:55]
  ds_read_b128 v[52:55], v79
  ds_write_b128 v78, v[56:59]
  ds_read_b128 v[56:59], v79
  s_cmp_lg_u32 s35, 1
  s_cbranch_scc1 LB0
  s_add_u32 s36, s56, 0x280000
  v_add_u32 v2, s36, v1
  v_mov_b32 v60, -1
  v_mov_b32 v61, -1
  v_mov_b32 v62, -1
  v_mov_b32 v63, -1
  global_store_dwordx4 v2, v[60:63], s[30:31] offset:0 sc1
  global_store_dwordx4 v2, v[60:63], s[30:31] offset:1024 sc1
LB0:
  s_waitcnt lgkmcnt(6)
  s_nop 0
  v_mfma_f32_16x16x32_bf16 v[60:63], v[28:31], v[44:47], 0
  v_xor_b32 v81, 16, v81
  ds_read_b128 v[28:31], v81 offset:0
  s_waitcnt lgkmcnt(7)
  v_mfma_f32_16x16x32_bf16 v[64:67], v[32:35], v[44:47], 0
  ds_read_b128 v[32:35], v81 offset:4096
  s_waitcnt lgkmcnt(8)
  v_mfma_f32_16x16x32_bf16 v[68:71], v[36:39], v[44:47], 0
  ds_read_b128 v[36:39], v81 offset:8192
  s_waitcnt lgkmcnt(9)
  v_mfma_f32_16x16x32_bf16 v[72:75], v[40:43], v[44:47], 0
  ds_read_b128 v[40:43], v81 offset:12288
  s_waitcnt lgkmcnt(3)
  v_mfma_f32_16x16x32_bf16 v[60:63], v[28:31], v[48:51], v[60:63]
  v_xor_b32 v81, 144, v81
  ds_read_b128 v[28:31], v81 offset:0
  s_lshr_b32 s46, s2, 6
  s_and_b32 s47, s2, 63
  s_lshl_b32 s36, s46, 6
  s_add_u32 s36, s36, s34
  s_waitcnt lgkmcnt(3)
  v_mfma_f32_16x16x32_bf16 v[64:67], v[32:35], v[48:51], v[64:67]
  ds_read_b128 v[32:35], v81 offset:4096
  s_lshl_b32 s36, s36, 7
  s_add_u32 s36, s36, s47
  s_lshl_b32 s36, s36, 7
  v_and_b32 v2, 15, v0
  s_waitcnt lgkmcnt(3)
  v_mfma_f32_16x16x32_bf16 v[68:71], v[36:39], v[48:51], v[68:71]
  ds_read_b128 v[36:39], v81 offset:8192
  v_lshlrev_b32 v2, 3, v2
  v_lshrrev_b32 v80, 4, v0
  v_lshlrev_b32 v80, 18, v80
  v_add3_u32 v80, v80, v2, s36
  s_waitcnt lgkmcnt(3)
  v_mfma_f32_16x16x32_bf16 v[72:75], v[40:43], v[48:51], v[72:75]
  ds_read_b128 v[40:43], v81 offset:12288
  s_add_u32 s36, s34, 1
  s_and_b32 s36, s36, 3
  s_mul_i32 s36, s36, 3072
  v_add_u32 v76, s36, v1
  s_waitcnt lgkmcnt(3)
  v_mfma_f32_16x16x32_bf16 v[60:63], v[28:31], v[52:55], v[60:63]
  v_xor_b32 v81, 16, v81
  ds_read_b128 v[28:31], v81 offset:0
  s_add_u32 s36, s34, 2
  s_and_b32 s36, s36, 3
  s_mul_i32 s36, s36, 3072
  v_add_u32 v77, s36, v1
  s_waitcnt lgkmcnt(3)
  v_mfma_f32_16x16x32_bf16 v[64:67], v[32:35], v[52:55], v[64:67]
  ds_read_b128 v[32:35], v81 offset:4096
  s_add_u32 s36, s34, 3
  s_and_b32 s36, s36, 3
  s_mul_i32 s36, s36, 3072
  v_add_u32 v83, s36, v1
  s_waitcnt lgkmcnt(3)
  v_mfma_f32_16x16x32_bf16 v[68:71], v[36:39], v[52:55], v[68:71]
  ds_read_b128 v[36:39], v81 offset:8192
  s_waitcnt lgkmcnt(3)
  v_mfma_f32_16x16x32_bf16 v[72:75], v[40:43], v[52:55], v[72:75]
  ds_read_b128 v[40:43], v81 offset:12288
  s_waitcnt lgkmcnt(3)
  v_mfma_f32_16x16x32_bf16 v[60:63], v[28:31], v[56:59], v[60:63]
  s_lshl_b32 s36, s2, 7
  s_add_u32 s36, s36, 983040
  v_add_u32 v81, s36, v2
  s_waitcnt lgkmcnt(2)
  v_mfma_f32_16x16x32_bf16 v[64:67], v[32:35], v[56:59], v[64:67]
  s_mul_i32 s36, s34, 3072
  v_add_u32 v2, s36, v1
  s_waitcnt lgkmcnt(1)
  v_mfma_f32_16x16x32_bf16 v[68:71], v[36:39], v[56:59], v[68:71]
  s_waitcnt lgkmcnt(0)
  v_mfma_f32_16x16x32_bf16 v[72:75], v[40:43], v[56:59], v[72:75]
  s_barrier
  s_nop 0
  ds_write_b128 v76, v[64:67] offset:0
  s_nop 2
  ds_write_b128 v77, v[68:71] offset:1024
  s_nop 0
  ds_write_b128 v83, v[72:75] offset:2048
  ds_read_b64_tr_b16 v[28:29], v82 offset:0
  ds_read_b64_tr_b16 v[30:31], v82 offset:4096
  ds_read_b64_tr_b16 v[32:33], v82 offset:8192
  ds_read_b64_tr_b16 v[34:35], v82 offset:12288
  v_xor_b32 v82, 32, v82
  ds_read_b64_tr_b16 v[36:37], v82 offset:0
  ds_read_b64_tr_b16 v[38:39], v82 offset:4096
  ds_read_b64_tr_b16 v[40:41], v82 offset:8192
  ds_read_b64_tr_b16 v[42:43], v82 offset:12288
  s_waitcnt lgkmcnt(8)
  s_barrier
  ds_read_b128 v[64:67], v2 offset:0
  ds_read_b128 v[68:71], v2 offset:1024
  ds_read_b128 v[72:75], v2 offset:2048
  s_waitcnt lgkmcnt(1)
  v_pk_add_f32 v[64:65], v[64:65], v[68:69]
  v_pk_add_f32 v[66:67], v[66:67], v[70:71]
  s_waitcnt lgkmcnt(0)
  v_pk_add_f32 v[60:61], v[60:61], v[72:73]
  v_pk_add_f32 v[62:63], v[62:63], v[74:75]
  v_pk_add_f32 v[60:61], v[60:61], v[64:65]
  v_pk_add_f32 v[62:63], v[62:63], v[66:67]
  ds_write_b128 v2, v[60:63]
  s_waitcnt lgkmcnt(0)
  s_barrier
  ds_read_b128 v[64:67], v76
  ds_read_b128 v[68:71], v77
  ds_read_b128 v[72:75], v83
  v_xor_b32 v82, 96, v82
  ds_read_b64_tr_b16 v[52:53], v82 offset:0
  ds_read_b64_tr_b16 v[54:55], v82 offset:4096
  ds_read_b64_tr_b16 v[56:57], v82 offset:8192
  ds_read_b64_tr_b16 v[58:59], v82 offset:12288
  s_waitcnt lgkmcnt(4)
  v_max3_f32 v76, v60, v61, v62
  v_max3_f32 v76, v76, v63, v64
  v_max3_f32 v76, v76, v65, v66
  v_max3_f32 v76, v76, v67, v68
  v_max3_f32 v76, v76, v69, v70
  v_max3_f32 v76, v76, v71, v72
  v_max3_f32 v76, v76, v73, v74
  v_max_f32 v76, v76, v75
  v_mov_b32 v77, v76
  s_nop 1
  v_permlane16_swap_b32 v76, v77
  v_max_f32 v76, v76, v77
  v_mov_b32 v77, v76
  s_nop 1
  v_permlane32_swap_b32 v76, v77
  v_max_f32 v76, v76, v77
  v_mul_f32 v76, s50, v76
  v_fma_f32 v60, v60, s50, -v76
  v_fma_f32 v61, v61, s50, -v76
  v_fma_f32 v62, v62, s50, -v76
  v_fma_f32 v63, v63, s50, -v76
  v_fma_f32 v64, v64, s50, -v76
  v_fma_f32 v65, v65, s50, -v76
  v_fma_f32 v66, v66, s50, -v76
  v_fma_f32 v67, v67, s50, -v76
  v_fma_f32 v68, v68, s50, -v76
  v_fma_f32 v69, v69, s50, -v76
  v_fma_f32 v70, v70, s50, -v76
  v_fma_f32 v71, v71, s50, -v76
  v_fma_f32 v72, v72, s50, -v76
  v_fma_f32 v73, v73, s50, -v76
  v_fma_f32 v74, v74, s50, -v76
  v_fma_f32 v75, v75, s50, -v76
  v_exp_f32 v60, v60
  v_exp_f32 v61, v61
  v_exp_f32 v62, v62
  v_exp_f32 v63, v63
  v_exp_f32 v64, v64
  v_exp_f32 v65, v65
  v_exp_f32 v66, v66
  v_exp_f32 v67, v67
  v_exp_f32 v68, v68
  v_exp_f32 v69, v69
  v_exp_f32 v70, v70
  v_exp_f32 v71, v71
  v_exp_f32 v72, v72
  v_exp_f32 v73, v73
  v_exp_f32 v74, v74
  v_exp_f32 v75, v75
  v_pk_add_f32 v[78:79], v[60:61], v[62:63]
  v_cvt_pk_bf16_f32 v60, v60, v61
  v_cvt_pk_bf16_f32 v61, v62, v63
  v_pk_add_f32 v[78:79], v[78:79], v[64:65]
  v_cvt_pk_bf16_f32 v62, v64, v65
  v_pk_add_f32 v[78:79], v[78:79], v[66:67]
  v_cvt_pk_bf16_f32 v63, v66, v67
  v_pk_add_f32 v[78:79], v[78:79], v[68:69]
  v_cvt_pk_bf16_f32 v64, v68, v69
  v_pk_add_f32 v[78:79], v[78:79], v[70:71]
  v_cvt_pk_bf16_f32 v65, v70, v71
  v_pk_add_f32 v[78:79], v[78:79], v[72:73]
  v_cvt_pk_bf16_f32 v66, v72, v73
  v_pk_add_f32 v[78:79], v[78:79], v[74:75]
  v_cvt_pk_bf16_f32 v67, v74, v75
  v_add_f32 v77, v78, v79
  s_waitcnt lgkmcnt(8)
  v_mfma_f32_16x16x32_bf16 v[68:71], v[60:63], v[28:31], 0
  v_mfma_f32_16x16x32_bf16 v[68:71], v[64:67], v[32:35], v[68:71]
  v_xor_b32 v82, 32, v82
  ds_read_b64_tr_b16 v[28:29], v82 offset:0
  ds_read_b64_tr_b16 v[30:31], v82 offset:4096
  ds_read_b64_tr_b16 v[32:33], v82 offset:8192
  ds_read_b64_tr_b16 v[34:35], v82 offset:12288
  v_mov_b32 v78, v77
  s_nop 1
  v_permlane16_swap_b32 v77, v78
  v_add_f32 v77, v77, v78
  v_mov_b32 v78, v77
  s_nop 1
  v_permlane32_swap_b32 v77, v78
  v_add_f32 v77, v77, v78
  s_cmp_eq_u32 s34, 0
  s_cbranch_scc0 LB1
  s_mov_b64 exec, 0xffff
  global_store_dwordx2 v81, v[76:77], s[40:41] sc1
  s_mov_b64 exec, -1
LB1:
  s_waitcnt lgkmcnt(8)
  v_mfma_f32_16x16x32_bf16 v[72:75], v[60:63], v[36:39], 0
  v_mfma_f32_16x16x32_bf16 v[72:75], v[64:67], v[40:43], v[72:75]
  v_xor_b32 v82, 224, v82
  ds_read_b64_tr_b16 v[36:37], v82 offset:0
  ds_read_b64_tr_b16 v[38:39], v82 offset:4096
  ds_read_b64_tr_b16 v[40:41], v82 offset:8192
  ds_read_b64_tr_b16 v[42:43], v82 offset:12288
  s_waitcnt lgkmcnt(8)
  v_mfma_f32_16x16x32_bf16 v[76:79], v[60:63], v[52:55], 0
  v_mfma_f32_16x16x32_bf16 v[76:79], v[64:67], v[56:59], v[76:79]
  v_xor_b32 v82, 32, v82
  ds_read_b64_tr_b16 v[52:53], v82 offset:0
  ds_read_b64_tr_b16 v[54:55], v82 offset:4096
  ds_read_b64_tr_b16 v[56:57], v82 offset:8192
  ds_read_b64_tr_b16 v[58:59], v82 offset:12288
  v_cvt_pk_bf16_f32 v44, v68, v72
  v_cvt_pk_bf16_f32 v46, v69, v73
  v_cvt_pk_bf16_f32 v48, v70, v74
  v_cvt_pk_bf16_f32 v50, v71, v75
  s_waitcnt lgkmcnt(8)
  v_mfma_f32_16x16x32_bf16 v[68:71], v[60:63], v[28:31], 0
  v_mfma_f32_16x16x32_bf16 v[68:71], v[64:67], v[32:35], v[68:71]
  v_xor_b32 v82, 96, v82
  ds_read_b64_tr_b16 v[28:29], v82 offset:0
  ds_read_b64_tr_b16 v[30:31], v82 offset:4096
  ds_read_b64_tr_b16 v[32:33], v82 offset:8192
  ds_read_b64_tr_b16 v[34:35], v82 offset:12288
  s_waitcnt lgkmcnt(8)
  v_mfma_f32_16x16x32_bf16 v[72:75], v[60:63], v[36:39], 0
  v_mfma_f32_16x16x32_bf16 v[72:75], v[64:67], v[40:43], v[72:75]
  v_xor_b32 v82, 32, v82
  ds_read_b64_tr_b16 v[36:37], v82 offset:0
  ds_read_b64_tr_b16 v[38:39], v82 offset:4096
  ds_read_b64_tr_b16 v[40:41], v82 offset:8192
  ds_read_b64_tr_b16 v[42:43], v82 offset:12288
  v_cvt_pk_bf16_f32 v45, v76, v68
  global_store_dwordx2 v80, v[44:45], s[44:45] sc1
  v_add_u32 v80, 65536, v80
  v_cvt_pk_bf16_f32 v47, v77, v69
  global_store_dwordx2 v80, v[46:47], s[44:45] sc1
  v_add_u32 v80, 65536, v80
  v_cvt_pk_bf16_f32 v49, v78, v70
  global_store_dwordx2 v80, v[48:49], s[44:45] sc1
  v_add_u32 v80, 65536, v80
  v_cvt_pk_bf16_f32 v51, v79, v71
  global_store_dwordx2 v80, v[50:51], s[44:45] sc1
  v_add_u32 v80, 4294778880, v80
  s_waitcnt lgkmcnt(8)
  v_mfma_f32_16x16x32_bf16 v[76:79], v[60:63], v[52:55], 0
  v_mfma_f32_16x16x32_bf16 v[76:79], v[64:67], v[56:59], v[76:79]
  s_waitcnt lgkmcnt(4)
  v_mfma_f32_16x16x32_bf16 v[68:71], v[60:63], v[28:31], 0
  v_mfma_f32_16x16x32_bf16 v[68:71], v[64:67], v[32:35], v[68:71]
  s_nop 4
  v_cvt_pk_bf16_f32 v44, v72, v76
  v_cvt_pk_bf16_f32 v46, v73, v77
  v_cvt_pk_bf16_f32 v48, v74, v78
  v_cvt_pk_bf16_f32 v50, v75, v79
  s_waitcnt lgkmcnt(0)
  v_mfma_f32_16x16x32_bf16 v[72:75], v[60:63], v[36:39], 0
  v_mfma_f32_16x16x32_bf16 v[72:75], v[64:67], v[40:43], v[72:75]
  s_nop 7
  v_cvt_pk_bf16_f32 v45, v68, v72
  global_store_dwordx2 v80, v[44:45], s[44:45] sc1
  v_add_u32 v80, 65536, v80
  v_cvt_pk_bf16_f32 v47, v69, v73
  global_store_dwordx2 v80, v[46:47], s[44:45] sc1
  v_add_u32 v80, 65536, v80
  v_cvt_pk_bf16_f32 v49, v70, v74
  global_store_dwordx2 v80, v[48:49], s[44:45] sc1
  v_add_u32 v80, 65536, v80
  v_cvt_pk_bf16_f32 v51, v71, v75
  global_store_dwordx2 v80, v[50:51], s[44:45] sc1
  v_add_u32 v80, 4294778880, v80
  s_lshl_b32 s36, s32, 2
  s_add_u32 s36, s36, s34
  s_lshl_b32 s36, s36, 8
  s_add_u32 s36, s36, s33
  s_lshl_b32 s36, s36, 7
  v_lshrrev_b32 v68, 3, v0
  v_lshlrev_b32 v68, 10, v68
  v_and_b32 v2, 0x70, v1
  v_add3_u32 v68, v68, v2, s36
  s_lshr_b32 s47, s34, 1
  s_and_b32 s46, s34, 1
  s_lshl_b32 s36, s47, 1
  s_lshr_b32 s47, s32, 4
  s_add_u32 s36, s36, s47
  s_lshl_b32 s36, s36, 1
  s_add_u32 s36, s36, s46
  s_lshl_b32 s36, s36, 9
  s_and_b32 s47, s32, 15
  s_add_u32 s36, s36, s47
  s_lshl_b32 s36, s36, 3
  s_add_u32 s36, s36, 983040
  v_and_b32 v78, 0x380, v1
  v_add_u32 v78, s36, v78
  s_lshl_b32 s36, s34, 8
  s_add_u32 s36, s36, 8192
  v_lshlrev_b32 v76, 1, v1
  v_and_b32 v76, 0xe0, v76
  v_lshrrev_b32 v2, 1, v0
  v_and_b32 v2, 24, v2
  v_add3_u32 v76, v76, v2, s36
  s_lshl_b32 s36, s34, 10
  s_add_u32 s36, s36, 0
  v_add_u32 v79, s36, v1
  s_lshl_b32 s36, s55, 10
  s_add_u32 s36, s36, 524288
  v_add_u32 v80, s36, v1
  v_lshrrev_b32 v81, 4, v0
  v_add_u32 v81, s38, v81
  v_lshlrev_b32 v81, 13, v81
  v_and_b32 v2, 0xf0, v1
  v_add3_u32 v81, v81, v2, s39
  s_barrier
  s_sleep 16
  s_branch Lp5
Lp5r:
  s_sub_u32 s37, s37, 1
  s_cbranch_scc1 Lend
Lp5:
  global_load_dwordx2 v[60:61], v78, s[40:41] offset:0 sc1
  global_load_dwordx4 v[44:47], v1, s[64:65] offset:0 sc1
  global_load_dwordx2 v[62:63], v78, s[40:41] offset:1024 sc1
  global_load_dwordx4 v[48:51], v1, s[64:65] offset:1024 sc1
  global_load_dwordx2 v[64:65], v78, s[40:41] offset:2048 sc1
  global_load_dwordx4 v[52:55], v1, s[64:65] offset:2048 sc1
  global_load_dwordx2 v[66:67], v78, s[40:41] offset:3072 sc1
  global_load_dwordx4 v[56:59], v1, s[64:65] offset:3072 sc1
  s_waitcnt vmcnt(0)
Lp5c:
  v_max3_u32 v82, v44, v45, v46
  v_max3_u32 v82, v82, v47, v48
  v_max3_u32 v82, v82, v49, v50
  v_max3_u32 v82, v82, v51, v52
  v_max3_u32 v82, v82, v53, v54
  v_max3_u32 v82, v82, v55, v56
  v_max3_u32 v82, v82, v57, v58
  v_max3_u32 v82, v82, v59, v60
  v_max3_u32 v82, v82, v61, v62
  v_max3_u32 v82, v82, v63, v64
  v_max3_u32 v82, v82, v65, v66
  v_max3_u32 v82, v82, v67, v67
  v_cmp_eq_u32 vcc, -1, v82
  s_cbranch_vccnz Lp5r
  global_load_dwordx4 v[28:31], v68, s[24:25]
  v_add_u32 v68, 8192, v68
  global_load_dwordx4 v[32:35], v68, s[24:25]
  v_add_u32 v68, 8192, v68
  global_load_dwordx4 v[36:39], v68, s[24:25]
  v_add_u32 v68, 8192, v68
  global_load_dwordx4 v[40:43], v68, s[24:25]
  v_max3_f32 v82, v60, v62, v64
  v_max_f32 v82, v82, v66
  s_nop 1
  v_max_f32_dpp v82, v82, v82 row_ror:8 row_mask:0xf bank_mask:0xf
  v_mov_b32 v83, v82
  s_nop 1
  v_permlane16_swap_b32 v82, v83
  v_max_f32 v82, v82, v83
  v_mov_b32 v83, v82
  s_nop 1
  v_permlane32_swap_b32 v82, v83
  v_max_f32 v82, v82, v83
  v_sub_f32 v60, v60, v82
  v_sub_f32 v62, v62, v82
  v_sub_f32 v64, v64, v82
  v_sub_f32 v66, v66, v82
  v_exp_f32 v60, v60
  v_exp_f32 v62, v62
  v_exp_f32 v64, v64
  v_exp_f32 v66, v66
  v_cvt_pk_bf16_f32 v60, 0, v60
  v_cvt_pk_bf16_f32 v62, 0, v62
  v_cvt_pk_bf16_f32 v64, 0, v64
  v_cvt_pk_bf16_f32 v66, 0, v66
  v_mul_f32 v83, v60, v61
  v_fmac_f32 v83, v62, v63
  v_fmac_f32 v83, v64, v65
  v_fmac_f32 v83, v66, v67
  v_lshrrev_b32 v61, 16, v60
  v_lshrrev_b32 v63, 16, v62
  v_lshrrev_b32 v65, 16, v64
  v_lshrrev_b32 v67, 16, v66
  v_dot2_f32_bf16 v68, v44, v61, 0
  v_dot2_f32_bf16 v69, v44, v60, 0
  v_dot2_f32_bf16 v70, v45, v61, 0
  v_dot2_f32_bf16 v71, v45, v60, 0
  v_dot2_f32_bf16 v72, v46, v61, 0
  v_dot2_f32_bf16 v73, v46, v60, 0
  v_dot2_f32_bf16 v74, v47, v61, 0
  v_dot2_f32_bf16 v75, v47, v60, 0
  v_dot2_f32_bf16 v68, v48, v63, v68
  v_dot2_f32_bf16 v69, v48, v62, v69
  v_dot2_f32_bf16 v70, v49, v63, v70
  v_dot2_f32_bf16 v71, v49, v62, v71
  v_dot2_f32_bf16 v72, v50, v63, v72
  v_dot2_f32_bf16 v73, v50, v62, v73
  v_dot2_f32_bf16 v74, v51, v63, v74
  v_dot2_f32_bf16 v75, v51, v62, v75
  v_dot2_f32_bf16 v68, v52, v65, v68
  v_dot2_f32_bf16 v69, v52, v64, v69
  v_dot2_f32_bf16 v70, v53, v65, v70
  v_dot2_f32_bf16 v71, v53, v64, v71
  v_dot2_f32_bf16 v72, v54, v65, v72
  v_dot2_f32_bf16 v73, v54, v64, v73
  v_dot2_f32_bf16 v74, v55, v65, v74
  v_dot2_f32_bf16 v75, v55, v64, v75
  v_dot2_f32_bf16 v68, v56, v67, v68
  v_dot2_f32_bf16 v69, v56, v66, v69
  v_dot2_f32_bf16 v70, v57, v67, v70
  v_dot2_f32_bf16 v71, v57, v66, v71
  v_dot2_f32_bf16 v72, v58, v67, v72
  v_dot2_f32_bf16 v73, v58, v66, v73
  v_dot2_f32_bf16 v74, v59, v67, v74
  v_dot2_f32_bf16 v75, v59, v66, v75
  v_mov_b32 v60, v83
  s_lshl_b32 s36, s34, 3
  v_mov_b32 v2, s36
  v_permlane32_swap_b32 v83, v60
  v_permlane32_swap_b32 v68, v72
  v_permlane32_swap_b32 v69, v73
  v_permlane32_swap_b32 v70, v74
  v_permlane32_swap_b32 v71, v75
  v_add_f32 v83, v83, v60
  v_add_f32 v68, v68, v72
  v_add_f32 v69, v69, v73
  v_add_f32 v70, v70, v74
  v_add_f32 v71, v71, v75
  v_mov_b32 v60, v83
  v_permlane16_swap_b32 v68, v70
  v_permlane16_swap_b32 v69, v71
  v_permlane16_swap_b32 v83, v60
  v_add_f32 v68, v68, v70
  v_add_f32 v69, v69, v71
  v_add_f32 v83, v83, v60
  v_add_f32_dpp v68, v68, v68 row_ror:8 row_mask:0xf bank_mask:0xf
  v_add_f32_dpp v69, v69, v69 row_ror:8 row_mask:0xf bank_mask:0xf
  v_add_f32_dpp v83, v83, v83 row_ror:8 row_mask:0xf bank_mask:0xf
  ds_write_b64 v76, v[68:69]
  ds_write_b64 v2, v[82:83] offset:6912
  v_and_b32 v2, 8, v0
  v_and_b32 v76, 48, v0
  v_lshl_add_u32 v76, v2, 6, v76
  s_lshl_b32 s36, s34, 6
  v_add_u32 v76, s36, v76
  v_lshlrev_b32 v2, 1, v2
  s_waitcnt lgkmcnt(0)
  s_barrier
  ds_read_b128 v[60:63], v2 offset:6912
  ds_read_b128 v[68:71], v76 offset:8192
  ds_read_b128 v[72:75], v76 offset:8448
  s_waitcnt lgkmcnt(2)
  v_max_f32 v82, v60, v62
  v_sub_f32 v60, v60, v82
  v_sub_f32 v62, v62, v82
  v_exp_f32 v60, v60
  v_exp_f32 v62, v62
  v_mul_f32 v82, v60, v61
  v_fmac_f32 v82, v62, v63
  v_rcp_f32 v82, v82
  s_waitcnt lgkmcnt(0)
  v_mul_f32 v68, v68, v60
  v_mul_f32 v69, v69, v60
  v_mul_f32 v70, v70, v60
  v_mul_f32 v71, v71, v60
  v_fmac_f32 v68, v72, v62
  v_fmac_f32 v69, v73, v62
  v_fmac_f32 v70, v74, v62
  v_fmac_f32 v71, v75, v62
  v_mul_f32 v68, v68, v82
  v_mul_f32 v69, v69, v82
  v_mul_f32 v70, v70, v82
  v_mul_f32 v71, v71, v82
  v_cvt_pk_bf16_f32 v68, v68, v68
  v_cvt_pk_bf16_f32 v69, v69, v69
  v_cvt_pk_bf16_f32 v70, v70, v70
  v_cvt_pk_bf16_f32 v71, v71, v71
  v_and_b32 v44, v68, v4
  v_and_b32 v45, v68, v5
  v_and_b32 v46, v68, v6
  v_and_b32 v47, v68, v7
  s_nop 1
  v_mfma_f32_16x16x32_bf16 v[60:63], v[12:15], v[44:47], 0
  v_and_b32 v48, v69, v4
  v_and_b32 v49, v69, v5
  v_and_b32 v50, v69, v6
  v_and_b32 v51, v69, v7
  s_nop 1
  v_mfma_f32_16x16x32_bf16 v[60:63], v[16:19], v[48:51], v[60:63]
  v_and_b32 v44, v70, v4
  v_and_b32 v45, v70, v5
  v_and_b32 v46, v70, v6
  v_and_b32 v47, v70, v7
  s_nop 1
  v_mfma_f32_16x16x32_bf16 v[60:63], v[20:23], v[44:47], v[60:63]
  v_and_b32 v48, v71, v4
  v_and_b32 v49, v71, v5
  v_and_b32 v50, v71, v6
  v_and_b32 v51, v71, v7
  s_nop 1
  v_mfma_f32_16x16x32_bf16 v[60:63], v[24:27], v[48:51], v[60:63]
  s_nop 7
  ds_write_b128 v79, v[60:63]
  s_waitcnt lgkmcnt(0)
  s_barrier
  s_cmp_eq_u32 s34, 0
  s_cbranch_scc0 LB2
  ds_read_b128 v[44:47], v79 offset:0
  ds_read_b128 v[48:51], v79 offset:1024
  ds_read_b128 v[52:55], v79 offset:2048
  ds_read_b128 v[56:59], v79 offset:3072
  s_waitcnt lgkmcnt(2)
  v_pk_add_f32 v[44:45], v[44:45], v[48:49]
  v_pk_add_f32 v[46:47], v[46:47], v[50:51]
  s_waitcnt lgkmcnt(0)
  v_pk_add_f32 v[52:53], v[52:53], v[56:57]
  v_pk_add_f32 v[54:55], v[54:55], v[58:59]
  v_pk_add_f32 v[44:45], v[44:45], v[52:53]
  v_pk_add_f32 v[46:47], v[46:47], v[54:55]
  s_cmp_eq_u32 s62, 0
  s_cbranch_scc1 Ls4
  global_store_dwordx4 v80, v[44:47], s[40:41]
  s_branch Ls4e
Ls4:
  global_store_dwordx4 v80, v[44:47], s[40:41] sc1
Ls4e:
LB2:
  s_lshl_b32 s36, s32, 13
  s_lshl_b32 s46, s34, 8
  s_add_u32 s36, s36, s46
  s_add_u32 s36, s36, 524288
  v_lshrrev_b32 v60, 3, v0
  v_lshlrev_b32 v60, 10, v60
  v_and_b32 v2, 0x70, v1
  v_add3_u32 v60, v60, v2, s36
  s_lshl_b32 s36, s34, 10
  s_add_u32 s36, s36, 8192
  v_lshlrev_b32 v74, 1, v0
  v_and_b32 v74, 0x70, v74
  v_add_u32 v74, s36, v74
  v_lshrrev_b32 v73, 2, v0
  v_and_b32 v73, 12, v73
  v_add3_u32 v73, v73, v2, s36
  s_branch Lp6
Lp6r:
  s_sub_u32 s37, s37, 1
  s_cbranch_scc1 Lend
Lp6:
  global_load_dwordx4 v[44:47], v60, s[40:41] sc1
  global_load_dwordx4 v[48:51], v60, s[40:41] offset:128 sc1
  s_waitcnt vmcnt(0)
Lp6c:
  v_max3_u32 v64, v44, v45, v46
  v_max3_u32 v64, v64, v47, v48
  v_max3_u32 v64, v64, v49, v50
  v_max3_u32 v64, v64, v51, v51
  v_cmp_eq_u32 vcc, -1, v64
  s_cbranch_vccnz Lp6r
  v_permlane32_swap_b32 v44, v46
  v_permlane32_swap_b32 v45, v47
  v_permlane32_swap_b32 v48, v50
  v_permlane32_swap_b32 v49, v51
  v_add_f32 v44, v44, v46
  v_add_f32 v45, v45, v47
  v_add_f32 v48, v48, v50
  v_add_f32 v49, v49, v51
  v_permlane16_swap_b32 v44, v45
  s_nop 0
  v_permlane16_swap_b32 v48, v49
  v_add_f32 v44, v44, v45
  v_add_f32 v48, v48, v49
  s_nop 0
  v_add_f32_dpp v44, v44, v44 row_ror:8 row_mask:0xf bank_mask:0xf
  v_add_f32_dpp v48, v48, v48 row_ror:8 row_mask:0xf bank_mask:0xf
  v_cvt_pk_bf16_f32 v44, v44, v44
  v_cvt_pk_bf16_f32 v48, v48, v48
  ds_write_b32 v73, v44
  ds_write_b32 v73, v48 offset:128
  s_cmp_lg_u32 s35, 1
  s_cbranch_scc1 LB4
  global_load_dwordx4 v[12:15], v81, s[10:11]
  v_add_u32 v81, 65536, v81
  global_load_dwordx4 v[16:19], v81, s[10:11]
  v_add_u32 v81, 65536, v81
  global_load_dwordx4 v[20:23], v81, s[10:11]
  v_add_u32 v81, 65536, v81
  global_load_dwordx4 v[24:27], v81, s[10:11]
LB4:
LWO:
  ds_read_b128 v[44:47], v74
  ds_read_b128 v[48:51], v74 offset:128
  s_waitcnt lgkmcnt(1)
  v_and_b32 v52, v44, v4
  v_and_b32 v53, v44, v5
  v_and_b32 v54, v44, v6
  v_and_b32 v55, v44, v7
  s_nop 1
  v_mfma_f32_16x16x32_bf16 v[60:63], v[28:31], v[52:55], 0
  v_and_b32 v56, v45, v4
  v_and_b32 v57, v45, v5
  v_and_b32 v58, v45, v6
  v_and_b32 v59, v45, v7
  s_nop 1
  v_mfma_f32_16x16x32_bf16 v[60:63], v[32:35], v[56:59], v[60:63]
  v_and_b32 v52, v46, v4
  v_and_b32 v53, v46, v5
  v_and_b32 v54, v46, v6
  v_and_b32 v55, v46, v7
  s_nop 1
  v_mfma_f32_16x16x32_bf16 v[60:63], v[36:39], v[52:55], v[60:63]
  v_and_b32 v56, v47, v4
  v_and_b32 v57, v47, v5
  v_and_b32 v58, v47, v6
  v_and_b32 v59, v47, v7
  s_nop 1
  v_mfma_f32_16x16x32_bf16 v[60:63], v[40:43], v[56:59], v[60:63]
  s_waitcnt lgkmcnt(0)
  v_and_b32 v52, v48, v4
  v_and_b32 v53, v48, v5
  v_and_b32 v54, v48, v6
  v_and_b32 v55, v48, v7
  s_nop 1
  v_mfma_f32_16x16x32_bf16 v[64:67], v[28:31], v[52:55], 0
  v_and_b32 v56, v49, v4
  v_and_b32 v57, v49, v5
  v_and_b32 v58, v49, v6
  v_and_b32 v59, v49, v7
  s_nop 1
  v_mfma_f32_16x16x32_bf16 v[64:67], v[32:35], v[56:59], v[64:67]
  v_and_b32 v52, v50, v4
  v_and_b32 v53, v50, v5
  v_and_b32 v54, v50, v6
  v_and_b32 v55, v50, v7
  s_nop 1
  v_mfma_f32_16x16x32_bf16 v[64:67], v[36:39], v[52:55], v[64:67]
  v_and_b32 v56, v51, v4
  v_and_b32 v57, v51, v5
  v_and_b32 v58, v51, v6
  v_and_b32 v59, v51, v7
  s_nop 1
  v_mfma_f32_16x16x32_bf16 v[64:67], v[40:43], v[56:59], v[64:67]
  s_lshl_b32 s36, s34, 10
  s_add_u32 s36, s36, 0
  v_and_b32 v68, 0x130, v1
  v_and_b32 v2, 4, v0
  v_lshl_add_u32 v68, v2, 5, v68
  v_and_b32 v2, 8, v0
  v_lshlrev_b32 v2, 6, v2
  v_add3_u32 v68, v68, v2, s36
  s_mov_b32 exec_lo, 0x00ff00ff
  s_mov_b32 exec_hi, 0xff00ff00
  ds_write_b128 v68, v[60:63]
  ds_write_b128 v68, v[64:67] offset:64
  s_mov_b64 exec, -1
  s_lshl_b32 s36, s33, 5
  s_add_u32 s36, s36, s32
  s_lshl_b32 s36, s36, 9
  s_add_u32 s36, s36, 786432
  v_and_b32 v69, 0x1f0, v1
  v_lshrrev_b32 v2, 2, v0
  v_and_b32 v2, 8, v2
  v_add3_u32 v69, v69, v2, s36
  v_add_u32 v70, 0, v1
  s_waitcnt lgkmcnt(0)
  s_barrier
  s_cmp_eq_u32 s34, 0
  s_cbranch_scc0 LW1
  ds_read_b128 v[44:47], v70 offset:0
  ds_read_b128 v[48:51], v70 offset:1024
  ds_read_b128 v[52:55], v70 offset:2048
  ds_read_b128 v[56:59], v70 offset:3072
  s_waitcnt lgkmcnt(2)
  v_pk_add_f32 v[44:45], v[44:45], v[48:49]
  v_pk_add_f32 v[46:47], v[46:47], v[50:51]
  s_waitcnt lgkmcnt(0)
  v_pk_add_f32 v[52:53], v[52:53], v[56:57]
  v_pk_add_f32 v[54:55], v[54:55], v[58:59]
  v_pk_add_f32 v[44:45], v[44:45], v[52:53]
  v_pk_add_f32 v[46:47], v[46:47], v[54:55]
  s_nop 1
  v_permlane32_swap_b32 v44, v46
  v_permlane32_swap_b32 v45, v47
  v_pk_add_f32 v[44:45], v[44:45], v[46:47]
  global_store_dwordx2 v69, v[44:45], s[40:41] sc1
LW1:
  s_mov_b64 s[42:43], s[40:41]
  s_add_u32 s40, s40, 0x100000
  s_addc_u32 s41, s41, 0
  s_add_u32 s35, s35, 1
  s_bitcmp1_b32 s35, 0
  s_cbranch_scc0 LW2
  s_lshl_b32 s36, s33, 2
  s_add_u32 s36, s36, s34
  s_lshl_b32 s36, s36, 17
  s_add_u32 s36, s36, s39
  v_lshrrev_b32 v60, 2, v0
  v_lshlrev_b32 v60, 13, v60
  v_and_b32 v2, 48, v1
  v_add3_u32 v60, v60, v2, s36
  global_load_dwordx4 v[28:31], v60, s[20:21] offset:0
  global_load_dwordx4 v[32:35], v60, s[20:21] offset:64
  global_load_dwordx4 v[36:39], v60, s[20:21] offset:128
  global_load_dwordx4 v[40:43], v60, s[20:21] offset:192
  s_sleep 11
  s_branch Lloop
LW2:
  s_cmp_eq_u32 s35, 4
  s_cbranch_scc1 LW3
  s_sleep 11
  s_waitcnt vmcnt(0)
  s_branch Lloop
LW3:
  s_cmp_eq_u32 s32, 0
  s_cbranch_scc0 Lfin
  s_sleep 11
  s_branch Lloop
Lout:
  v_lshrrev_b32 v60, 4, v0
  v_add_u32 v60, s38, v60
  v_and_b32 v2, 8, v0
  v_lshlrev_b32 v2, 6, v2
  v_add_lshl_u32 v60, v60, v2, 1
  s_mov_b32 exec_lo, 0x01010101
  s_mov_b32 exec_hi, 0x01010101
  global_store_short v60, v44, s[26:27] offset:0
  global_store_short v60, v45, s[26:27] offset:16
  global_store_short v60, v46, s[26:27] offset:32
  global_store_short v60, v47, s[26:27] offset:48
  s_mov_b64 exec, -1
Lfin:
Lend:
  s_endpgm
.section .rodata,"a"
.p2align 6
.amdhsa_kernel interleave_layers__mha_block_cached__compressed_kv_cla__decode_kernel
  .amdhsa_next_free_vgpr 512
  .amdhsa_next_free_sgpr 102
  .amdhsa_accum_offset 256
  .amdhsa_group_segment_fixed_size 0
  .amdhsa_kernarg_size 112
  .amdhsa_user_sgpr_count 2
  .amdhsa_user_sgpr_kernarg_segment_ptr 1
  .amdhsa_system_sgpr_workgroup_id_x 1
.end_amdhsa_kernel
```
